```python
import torch

def _softmax(x, axis=-1):
    return torch.softmax(x, dim=axis)

def _gelu(x):
    return torch.nn.functional.gelu(x, approximate='tanh')

def _silu(x):
    return torch.nn.functional.silu(x)

def _sigmoid(x):
    return torch.sigmoid(x)

def _layernorm(x, axis=-1, eps=1e-05):
    m = x.mean(dim=axis, keepdim=True)
    v = x.var(dim=axis, keepdim=True, unbiased=False)
    return (x - m) / torch.sqrt(v + eps)

def _scatter_add(tgt, idx, src, axis=0):
    return tgt.clone().index_add_(axis, idx, src)

def _segment_sum(src, seg, n):
    out = torch.zeros((n,) + src.shape[1:], dtype=src.dtype)
    return out.index_add_(0, seg, src)

def _pad(x, pw):
    flat = tuple((v for pair in reversed(pw) for v in pair))
    return torch.nn.functional.pad(x, flat)
kernel_name = 'interleave_layers__grouped_kv_mqa__memory_aug_recurrent_mem_tr__prompt'

def setup_inputs():

    _w = lambda a: (lambda t: t.to(torch.bfloat16) if t.is_floating_point() else t)(torch.as_tensor(a))

    def _A_setup():
        B, S, D, H = (1, 2048, 512, 32)
        Dh = D // H
        return {'x': _w((lambda *s: torch.randn(*s, dtype=torch.bfloat16) * 0.05)(B, S, D)), 'wq': _w((lambda *s: torch.randn(*s, dtype=torch.bfloat16) * 0.05)(D, H * Dh)), 'wk': _w((lambda *s: torch.randn(*s, dtype=torch.bfloat16) * 0.05)(D, Dh)), 'wv': _w((lambda *s: torch.randn(*s, dtype=torch.bfloat16) * 0.05)(D, Dh)), 'wo': _w((lambda *s: torch.randn(*s, dtype=torch.bfloat16) * 0.05)(H * Dh, D))}
    _A_in = _A_setup()

    def _B_setup():
        B, S, Dm = (1, 2048, 512)
        H, Dh = (32, 128)
        M, seg = (8, 32)
        seg = min(seg, S)
        S = S // seg * seg
        return {'x': _w((lambda *s: torch.randn(*s, dtype=torch.bfloat16) * 0.05)(B, S, Dm)), 'mem0': _w((lambda *s: torch.randn(*s, dtype=torch.bfloat16) * 0.8)(B, M, Dm)), 'Wq': _w((lambda *s: torch.randn(*s, dtype=torch.bfloat16) * 1.6)(Dm, H, Dh) * Dm ** (-0.5)), 'Wk': _w((lambda *s: torch.randn(*s, dtype=torch.bfloat16) * 1.6)(Dm, H, Dh) * Dm ** (-0.5)), 'Wv': _w((lambda *s: torch.randn(*s, dtype=torch.bfloat16) * 0.8)(Dm, H, Dh) * Dm ** (-0.5)), 'Wo': _w((lambda *s: torch.randn(*s, dtype=torch.bfloat16) * 0.8)(H, Dh, Dm) * (H * Dh) ** (-0.5)), 'seg_len': seg}
    _B_in = _B_setup()
    return {'A_x': _A_in['x'], 'A_wq': _A_in['wq'], 'A_wk': _A_in['wk'], 'A_wv': _A_in['wv'], 'A_wo': _A_in['wo'], 'B_x': _B_in['x'], 'B_mem0': _B_in['mem0'], 'B_Wq': _B_in['Wq'], 'B_Wk': _B_in['Wk'], 'B_Wv': _B_in['Wv'], 'B_Wo': _B_in['Wo'], 'B_seg_len': _B_in['seg_len']}

def reference(A_x, A_wq, A_wk, A_wv, A_wo, B_x, B_mem0, B_Wq, B_Wk, B_Wv, B_Wo, B_seg_len):

    def _A_ref(x, wq, wk, wv, wo):
        B, S, D = x.shape
        H = 32
        Dh = D // H
        q = (lambda x, *d: x.permute(*d))((x @ wq).reshape(B, S, H, Dh), 0, 2, 1, 3)
        k = x @ wk
        v = x @ wv
        scores = torch.einsum('bhqd,bkd->bhqk', q, k) * Dh ** (-0.5)
        p = _softmax(scores, axis=-1)
        o = torch.einsum('bhqk,bkd->bhqd', p, v)
        return (lambda x, *d: x.permute(*d))(o, 0, 2, 1, 3).reshape(B, S, H * Dh) @ wo

    def _B_ref(x, mem0, Wq, Wk, Wv, Wo, seg_len):
        B, S, Dm = x.shape
        H, Dh = (Wq.shape[1], Wq.shape[2])
        M = mem0.shape[1]
        scale = Dh ** (-0.5)
        n_seg = S // seg_len
        L = M + seg_len
        idx = torch.arange(L)
        mask = (idx[:, None] < M) | (idx[:, None] >= idx[None, :])
        mem = mem0
        outs = []
        for s in range(n_seg):
            xs = x[:, s * seg_len:(s + 1) * seg_len, :].clone()
            h = torch.concatenate([mem, xs], axis=1)
            q = torch.einsum('btd,dhe->bhte', h, Wq)
            k = torch.einsum('btd,dhe->bhte', h, Wk)
            v = torch.einsum('btd,dhe->bhte', h, Wv)
            scores = torch.einsum('bhqe,bhke->bhqk', q, k) * scale
            scores = torch.where(mask[None, None], scores, -1000000000.0)
            p = _softmax(scores, axis=-1)
            o = torch.einsum('bhqk,bhke->bhqe', p, v)
            o = torch.einsum('bhte,hed->btd', o, Wo)
            mem = o[:, :M, :].clone()
            outs.append(o[:, M:, :])
        return torch.concatenate(outs, axis=1)
    x = A_x
    x = x + _A_ref(_layernorm(x, axis=-1), A_wq, A_wk, A_wv, A_wo)
    x = x + _B_ref(_layernorm(x, axis=-1), B_mem0, B_Wq, B_Wk, B_Wv, B_Wo, B_seg_len)
    x = x + _A_ref(_layernorm(x, axis=-1), A_wq, A_wk, A_wv, A_wo)
    x = x + _B_ref(_layernorm(x, axis=-1), B_mem0, B_Wq, B_Wk, B_Wv, B_Wo, B_seg_len)
    return x
```

```asm
; @launch kernel=tr_kernel grid=(1128,1,1) block=(256,1,1) lds=0
; @launch kernel=ln_kernel grid=(512,1,1) block=(256,1,1) lds=0
; @launch kernel=g1_kernel grid=(80,1,1) block=(256,1,1) lds=73728
; @launch kernel=attna_kernel grid=(256,1,1) block=(512,1,1) lds=135168
; @launch kernel=g2_kernel grid=(256,1,1) block=(256,1,1) lds=36864
; @launch kernel=ln_kernel grid=(512,1,1) block=(256,1,1) lds=0
; @launch kernel=g3_kernel grid=(1024,1,1) block=(256,1,1) lds=73728
; @launch kernel=chain_kernel grid=(256,1,1) block=(256,1,1) lds=159744
; @launch kernel=attnb_kernel grid=(512,1,1) block=(256,1,1) lds=0
; @launch kernel=g4_kernel grid=(256,1,1) block=(256,1,1) lds=36864
; @launch kernel=ln_kernel grid=(512,1,1) block=(256,1,1) lds=0
; @launch kernel=g1_kernel grid=(80,1,1) block=(256,1,1) lds=73728
; @launch kernel=attna_kernel grid=(256,1,1) block=(512,1,1) lds=135168
; @launch kernel=g2_kernel grid=(256,1,1) block=(256,1,1) lds=36864
; @launch kernel=ln_kernel grid=(512,1,1) block=(256,1,1) lds=0
; @launch kernel=g3_kernel grid=(1024,1,1) block=(256,1,1) lds=73728
; @launch kernel=chain_kernel grid=(256,1,1) block=(256,1,1) lds=159744
; @launch kernel=attnb_kernel grid=(512,1,1) block=(256,1,1) lds=0
; @launch kernel=g4_kernel grid=(256,1,1) block=(256,1,1) lds=36864
.amdgcn_target "amdgcn-amd-amdhsa--gfx950"
.text
.globl tr_kernel
.p2align 8
.type tr_kernel,@function
tr_kernel:
  s_load_dwordx2 s[4:5], s[0:1], 112
  v_lshrrev_b32 v1, 6, v0
  v_and_b32 v0, 63, v0
  s_nop 1
  v_readfirstlane_b32 s3, v1
  s_nop 3
  s_lshl_b32 s16, s2, 2
  s_add_u32 s16, s16, s3
  s_cmp_lt_u32 s16, 128
  s_cbranch_scc1 .Ltr_kernel_m1
  s_sub_u32 s16, s16, 128
  s_cmp_lt_u32 s16, 16
  s_cbranch_scc1 .Ltr_kernel_m2
  s_sub_u32 s16, s16, 16
  s_cmp_lt_u32 s16, 16
  s_cbranch_scc1 .Ltr_kernel_m3
  s_sub_u32 s16, s16, 16
  s_cmp_lt_u32 s16, 128
  s_cbranch_scc1 .Ltr_kernel_m4
  s_sub_u32 s16, s16, 128
  s_cmp_lt_u32 s16, 1024
  s_cbranch_scc1 .Ltr_kernel_m5
  s_sub_u32 s16, s16, 1024
  s_cmp_lt_u32 s16, 1024
  s_cbranch_scc1 .Ltr_kernel_m6
  s_sub_u32 s16, s16, 1024
  s_cmp_lt_u32 s16, 1024
  s_cbranch_scc1 .Ltr_kernel_m7
  s_sub_u32 s16, s16, 1024
  s_cmp_lt_u32 s16, 1024
  s_cbranch_scc1 .Ltr_kernel_m8
  s_sub_u32 s16, s16, 1024
  s_cmp_lt_u32 s16, 128
  s_cbranch_scc1 .Ltr_kernel_copy9
  s_branch .Ltr_kernel_end11
  .Ltr_kernel_m1:
  s_load_dwordx2 s[8:9], s[0:1], 8
  s_mov_b32 s10, 0x80000
  s_mov_b32 s11, 0x00020000
  s_mov_b32 s17, 1024
  s_mov_b32 s18, 1024
  s_mov_b32 s20, 0x0
  s_mov_b32 s21, 512
  s_and_b32 s22, s16, 15
  s_lshr_b32 s23, s16, 4
  s_branch .Ltr_kernel_body10
  .Ltr_kernel_m2:
  s_load_dwordx2 s[8:9], s[0:1], 16
  s_mov_b32 s10, 0x4000
  s_mov_b32 s11, 0x00020000
  s_mov_b32 s17, 32
  s_mov_b32 s18, 1024
  s_mov_b32 s20, 0x80000
  s_mov_b32 s21, 16
  s_and_b32 s22, s16, 15
  s_lshr_b32 s23, s16, 4
  s_branch .Ltr_kernel_body10
  .Ltr_kernel_m3:
  s_load_dwordx2 s[8:9], s[0:1], 24
  s_mov_b32 s10, 0x4000
  s_mov_b32 s11, 0x00020000
  s_mov_b32 s17, 32
  s_mov_b32 s18, 1024
  s_mov_b32 s20, 0x84000
  s_mov_b32 s21, 16
  s_and_b32 s22, s16, 15
  s_lshr_b32 s23, s16, 4
  s_branch .Ltr_kernel_body10
  .Ltr_kernel_m4:
  s_load_dwordx2 s[8:9], s[0:1], 32
  s_mov_b32 s10, 0x80000
  s_mov_b32 s11, 0x00020000
  s_mov_b32 s17, 1024
  s_mov_b32 s18, 1024
  s_mov_b32 s20, 0x90000
  s_mov_b32 s21, 512
  s_and_b32 s22, s16, 15
  s_lshr_b32 s23, s16, 4
  s_branch .Ltr_kernel_body10
  .Ltr_kernel_m5:
  s_load_dwordx2 s[8:9], s[0:1], 56
  s_mov_b32 s10, 0x400000
  s_mov_b32 s11, 0x00020000
  s_mov_b32 s17, 8192
  s_mov_b32 s18, 1024
  s_mov_b32 s20, 0x110000
  s_mov_b32 s21, 4096
  s_and_b32 s22, s16, 15
  s_lshr_b32 s23, s16, 4
  s_branch .Ltr_kernel_body10
  .Ltr_kernel_m6:
  s_load_dwordx2 s[8:9], s[0:1], 64
  s_mov_b32 s10, 0x400000
  s_mov_b32 s11, 0x00020000
  s_mov_b32 s17, 8192
  s_mov_b32 s18, 1024
  s_mov_b32 s20, 0x510000
  s_mov_b32 s21, 4096
  s_and_b32 s22, s16, 15
  s_lshr_b32 s23, s16, 4
  s_branch .Ltr_kernel_body10
  .Ltr_kernel_m7:
  s_load_dwordx2 s[8:9], s[0:1], 72
  s_mov_b32 s10, 0x400000
  s_mov_b32 s11, 0x00020000
  s_mov_b32 s17, 8192
  s_mov_b32 s18, 1024
  s_mov_b32 s20, 0x910000
  s_mov_b32 s21, 4096
  s_and_b32 s22, s16, 15
  s_lshr_b32 s23, s16, 4
  s_branch .Ltr_kernel_body10
  .Ltr_kernel_m8:
  s_load_dwordx2 s[8:9], s[0:1], 80
  s_mov_b32 s10, 0x400000
  s_mov_b32 s11, 0x00020000
  s_mov_b32 s17, 1024
  s_mov_b32 s18, 8192
  s_mov_b32 s20, 0xd10000
  s_mov_b32 s21, 512
  s_and_b32 s22, s16, 127
  s_lshr_b32 s23, s16, 7
  s_branch .Ltr_kernel_body10
  .Ltr_kernel_copy9:
  s_load_dwordx2 s[8:9], s[0:1], 0
  s_waitcnt lgkmcnt(0)
  s_and_b32 s5, s5, 0xffff
  s_mov_b32 s6, 0x10000000
  s_mov_b32 s7, 0x00020000
  s_and_b32 s9, s9, 0xffff
  s_mov_b32 s10, 0x200000
  s_mov_b32 s11, 0x00020000
  s_lshl_b32 s16, s16, 14
  v_lshlrev_b32 v1, 4, v0
  v_add_u32 v1, s16, v1
  s_mov_b32 s20, 0x1110000
  buffer_load_dwordx4 v[4:7], v1, s[8:11], 0 offen offset:0
  buffer_load_dwordx4 v[8:11], v1, s[8:11], 0 offen offset:1024
  buffer_load_dwordx4 v[12:15], v1, s[8:11], 0 offen offset:2048
  buffer_load_dwordx4 v[16:19], v1, s[8:11], 0 offen offset:3072
  v_add_u32 v1, 0x1000, v1
  buffer_load_dwordx4 v[20:23], v1, s[8:11], 0 offen offset:0
  buffer_load_dwordx4 v[24:27], v1, s[8:11], 0 offen offset:1024
  buffer_load_dwordx4 v[28:31], v1, s[8:11], 0 offen offset:2048
  buffer_load_dwordx4 v[32:35], v1, s[8:11], 0 offen offset:3072
  v_add_u32 v1, 0x1000, v1
  s_waitcnt vmcnt(0)
  v_subrev_u32 v2, 0x2000, v1
  buffer_store_dwordx4 v[4:7], v2, s[4:7], s20 offen offset:0
  buffer_store_dwordx4 v[8:11], v2, s[4:7], s20 offen offset:1024
  buffer_store_dwordx4 v[12:15], v2, s[4:7], s20 offen offset:2048
  buffer_store_dwordx4 v[16:19], v2, s[4:7], s20 offen offset:3072
  v_add_u32 v2, 0x1000, v2
  buffer_store_dwordx4 v[20:23], v2, s[4:7], s20 offen offset:0
  buffer_store_dwordx4 v[24:27], v2, s[4:7], s20 offen offset:1024
  buffer_store_dwordx4 v[28:31], v2, s[4:7], s20 offen offset:2048
  buffer_store_dwordx4 v[32:35], v2, s[4:7], s20 offen offset:3072
  v_add_u32 v2, 0x1000, v2
  s_waitcnt vmcnt(0)
  buffer_load_dwordx4 v[4:7], v1, s[8:11], 0 offen offset:0
  buffer_load_dwordx4 v[8:11], v1, s[8:11], 0 offen offset:1024
  buffer_load_dwordx4 v[12:15], v1, s[8:11], 0 offen offset:2048
  buffer_load_dwordx4 v[16:19], v1, s[8:11], 0 offen offset:3072
  v_add_u32 v1, 0x1000, v1
  buffer_load_dwordx4 v[20:23], v1, s[8:11], 0 offen offset:0
  buffer_load_dwordx4 v[24:27], v1, s[8:11], 0 offen offset:1024
  buffer_load_dwordx4 v[28:31], v1, s[8:11], 0 offen offset:2048
  buffer_load_dwordx4 v[32:35], v1, s[8:11], 0 offen offset:3072
  v_add_u32 v1, 0x1000, v1
  s_waitcnt vmcnt(0)
  v_subrev_u32 v2, 0x2000, v1
  buffer_store_dwordx4 v[4:7], v2, s[4:7], s20 offen offset:0
  buffer_store_dwordx4 v[8:11], v2, s[4:7], s20 offen offset:1024
  buffer_store_dwordx4 v[12:15], v2, s[4:7], s20 offen offset:2048
  buffer_store_dwordx4 v[16:19], v2, s[4:7], s20 offen offset:3072
  v_add_u32 v2, 0x1000, v2
  buffer_store_dwordx4 v[20:23], v2, s[4:7], s20 offen offset:0
  buffer_store_dwordx4 v[24:27], v2, s[4:7], s20 offen offset:1024
  buffer_store_dwordx4 v[28:31], v2, s[4:7], s20 offen offset:2048
  buffer_store_dwordx4 v[32:35], v2, s[4:7], s20 offen offset:3072
  v_add_u32 v2, 0x1000, v2
  s_waitcnt vmcnt(0)
  s_branch .Ltr_kernel_end11
  .Ltr_kernel_body10:
  s_waitcnt lgkmcnt(0)
  s_and_b32 s5, s5, 0xffff
  s_mov_b32 s6, 0x10000000
  s_mov_b32 s7, 0x00020000
  s_and_b32 s9, s9, 0xffff
  s_lshl_b32 s23, s23, 6
  v_add_u32 v1, s23, v0
  v_cmp_gt_u32 vcc, s21, v1
  s_and_saveexec_b64 s[24:25], vcc
  s_lshl_b32 s22, s22, 5
  s_mul_i32 s26, s22, s17
  v_lshlrev_b32 v2, 1, v1
  v_add_u32 v2, s26, v2
  buffer_load_ushort v10, v2, s[8:11], 0 offen
  v_add_u32 v2, s17, v2
  buffer_load_short_d16_hi v30, v2, s[8:11], 0 offen
  v_add_u32 v2, s17, v2
  buffer_load_ushort v11, v2, s[8:11], 0 offen
  v_add_u32 v2, s17, v2
  buffer_load_short_d16_hi v31, v2, s[8:11], 0 offen
  v_add_u32 v2, s17, v2
  buffer_load_ushort v12, v2, s[8:11], 0 offen
  v_add_u32 v2, s17, v2
  buffer_load_short_d16_hi v32, v2, s[8:11], 0 offen
  v_add_u32 v2, s17, v2
  buffer_load_ushort v13, v2, s[8:11], 0 offen
  v_add_u32 v2, s17, v2
  buffer_load_short_d16_hi v33, v2, s[8:11], 0 offen
  v_add_u32 v2, s17, v2
  buffer_load_ushort v14, v2, s[8:11], 0 offen
  v_add_u32 v2, s17, v2
  buffer_load_short_d16_hi v34, v2, s[8:11], 0 offen
  v_add_u32 v2, s17, v2
  buffer_load_ushort v15, v2, s[8:11], 0 offen
  v_add_u32 v2, s17, v2
  buffer_load_short_d16_hi v35, v2, s[8:11], 0 offen
  v_add_u32 v2, s17, v2
  buffer_load_ushort v16, v2, s[8:11], 0 offen
  v_add_u32 v2, s17, v2
  buffer_load_short_d16_hi v36, v2, s[8:11], 0 offen
  v_add_u32 v2, s17, v2
  buffer_load_ushort v17, v2, s[8:11], 0 offen
  v_add_u32 v2, s17, v2
  buffer_load_short_d16_hi v37, v2, s[8:11], 0 offen
  v_add_u32 v2, s17, v2
  buffer_load_ushort v18, v2, s[8:11], 0 offen
  v_add_u32 v2, s17, v2
  buffer_load_short_d16_hi v38, v2, s[8:11], 0 offen
  v_add_u32 v2, s17, v2
  buffer_load_ushort v19, v2, s[8:11], 0 offen
  v_add_u32 v2, s17, v2
  buffer_load_short_d16_hi v39, v2, s[8:11], 0 offen
  v_add_u32 v2, s17, v2
  buffer_load_ushort v20, v2, s[8:11], 0 offen
  v_add_u32 v2, s17, v2
  buffer_load_short_d16_hi v40, v2, s[8:11], 0 offen
  v_add_u32 v2, s17, v2
  buffer_load_ushort v21, v2, s[8:11], 0 offen
  v_add_u32 v2, s17, v2
  buffer_load_short_d16_hi v41, v2, s[8:11], 0 offen
  v_add_u32 v2, s17, v2
  buffer_load_ushort v22, v2, s[8:11], 0 offen
  v_add_u32 v2, s17, v2
  buffer_load_short_d16_hi v42, v2, s[8:11], 0 offen
  v_add_u32 v2, s17, v2
  buffer_load_ushort v23, v2, s[8:11], 0 offen
  v_add_u32 v2, s17, v2
  buffer_load_short_d16_hi v43, v2, s[8:11], 0 offen
  v_add_u32 v2, s17, v2
  buffer_load_ushort v24, v2, s[8:11], 0 offen
  v_add_u32 v2, s17, v2
  buffer_load_short_d16_hi v44, v2, s[8:11], 0 offen
  v_add_u32 v2, s17, v2
  buffer_load_ushort v25, v2, s[8:11], 0 offen
  v_add_u32 v2, s17, v2
  buffer_load_short_d16_hi v45, v2, s[8:11], 0 offen
  v_add_u32 v2, s17, v2
  v_mul_lo_u32 v3, v1, s18
  s_lshl_b32 s27, s22, 1
  v_add_u32 v3, s27, v3
  s_waitcnt vmcnt(0)
  v_or_b32 v10, v10, v30
  v_or_b32 v11, v11, v31
  v_or_b32 v12, v12, v32
  v_or_b32 v13, v13, v33
  v_or_b32 v14, v14, v34
  v_or_b32 v15, v15, v35
  v_or_b32 v16, v16, v36
  v_or_b32 v17, v17, v37
  v_or_b32 v18, v18, v38
  v_or_b32 v19, v19, v39
  v_or_b32 v20, v20, v40
  v_or_b32 v21, v21, v41
  v_or_b32 v22, v22, v42
  v_or_b32 v23, v23, v43
  v_or_b32 v24, v24, v44
  v_or_b32 v25, v25, v45
  buffer_store_dwordx4 v[10:13], v3, s[4:7], s20 offen
  buffer_store_dwordx4 v[14:17], v3, s[4:7], s20 offen offset:16
  buffer_store_dwordx4 v[18:21], v3, s[4:7], s20 offen offset:32
  buffer_store_dwordx4 v[22:25], v3, s[4:7], s20 offen offset:48
  .Ltr_kernel_end11:
  s_endpgm

.globl ln_kernel
.p2align 8
.type ln_kernel,@function
ln_kernel:
  s_cmp_ge_u32 s2, 512
  s_cbranch_scc1 .Lln_kernel_end1
  s_load_dwordx2 s[4:5], s[0:1], 112
  s_waitcnt lgkmcnt(0)
  s_and_b32 s5, s5, 0xffff
  s_mov_b32 s6, 0x10000000
  s_mov_b32 s7, 0x00020000
  v_lshrrev_b32 v1, 6, v0
  v_and_b32 v2, 63, v0
  s_lshl_b32 s16, s2, 2
  v_add_u32 v1, s16, v1
  v_lshlrev_b32 v3, 10, v1
  v_lshl_add_u32 v3, v2, 4, v3
  s_mov_b32 s17, 0x1110000
  s_mov_b32 s18, 0x1310000
  buffer_load_dwordx4 v[4:7], v3, s[4:7], s17 offen
  s_lshl_b32 s19, s2, 12
  v_lshl_add_u32 v30, v0, 4, s19
  v_mov_b32 v32, 0
  v_mov_b32 v33, 0
  v_mov_b32 v34, 0
  v_mov_b32 v35, 0
  s_mov_b32 s20, 0x110000
  v_cmp_gt_u32 vcc, s20, v30
  s_and_saveexec_b64 s[24:25], vcc
  s_mov_b32 s21, 0x6130000
  buffer_store_dwordx4 v[32:35], v30, s[4:7], s21 offen
  s_mov_b64 exec, s[24:25]
  s_waitcnt vmcnt(1)
  v_lshlrev_b32 v8, 16, v4
  v_and_b32 v9, 0xffff0000, v4
  v_lshlrev_b32 v10, 16, v5
  v_and_b32 v11, 0xffff0000, v5
  v_lshlrev_b32 v12, 16, v6
  v_and_b32 v13, 0xffff0000, v6
  v_lshlrev_b32 v14, 16, v7
  v_and_b32 v15, 0xffff0000, v7
  v_add_f32 v20, v8, v9
  v_add_f32 v21, v10, v11
  v_add_f32 v22, v12, v13
  v_add_f32 v23, v14, v15
  v_add_f32 v20, v20, v21
  v_add_f32 v22, v22, v23
  v_add_f32 v20, v20, v22
  s_nop 1
  v_add_f32_dpp v20, v20, v20 row_ror:8 row_mask:0xf bank_mask:0xf
  s_nop 1
  v_add_f32_dpp v20, v20, v20 row_ror:4 row_mask:0xf bank_mask:0xf
  s_nop 1
  v_add_f32_dpp v20, v20, v20 row_ror:2 row_mask:0xf bank_mask:0xf
  s_nop 1
  v_add_f32_dpp v20, v20, v20 row_ror:1 row_mask:0xf bank_mask:0xf
  s_nop 1
  v_mov_b32 v21, v20
  s_nop 1
  v_permlane16_swap_b32 v20, v21
  v_add_f32 v20, v20, v21
  v_mov_b32 v21, v20
  s_nop 1
  v_permlane32_swap_b32 v20, v21
  v_add_f32 v20, v20, v21
  v_mul_f32 v20, 0x3b000000, v20
  v_sub_f32 v22, v8, v20
  v_sub_f32 v23, v9, v20
  v_sub_f32 v24, v10, v20
  v_sub_f32 v25, v11, v20
  v_sub_f32 v26, v12, v20
  v_sub_f32 v27, v13, v20
  v_sub_f32 v28, v14, v20
  v_sub_f32 v29, v15, v20
  v_mul_f32 v21, v22, v22
  v_fma_f32 v21, v23, v23, v21
  v_fma_f32 v21, v24, v24, v21
  v_fma_f32 v21, v25, v25, v21
  v_fma_f32 v21, v26, v26, v21
  v_fma_f32 v21, v27, v27, v21
  v_fma_f32 v21, v28, v28, v21
  v_fma_f32 v21, v29, v29, v21
  s_nop 1
  v_add_f32_dpp v21, v21, v21 row_ror:8 row_mask:0xf bank_mask:0xf
  s_nop 1
  v_add_f32_dpp v21, v21, v21 row_ror:4 row_mask:0xf bank_mask:0xf
  s_nop 1
  v_add_f32_dpp v21, v21, v21 row_ror:2 row_mask:0xf bank_mask:0xf
  s_nop 1
  v_add_f32_dpp v21, v21, v21 row_ror:1 row_mask:0xf bank_mask:0xf
  s_nop 1
  v_mov_b32 v31, v21
  s_nop 1
  v_permlane16_swap_b32 v21, v31
  v_add_f32 v21, v21, v31
  v_mov_b32 v31, v21
  s_nop 1
  v_permlane32_swap_b32 v21, v31
  v_add_f32 v21, v21, v31
  v_mul_f32 v21, 0x3b000000, v21
  v_cvt_pk_bf16_f32 v20, v20, v20
  v_lshlrev_b32 v20, 16, v20
  v_cvt_pk_bf16_f32 v21, v21, v21
  v_lshlrev_b32 v21, 16, v21
  v_add_f32 v21, 0x3727c5ac, v21
  v_cvt_pk_bf16_f32 v21, v21, v21
  v_lshlrev_b32 v21, 16, v21
  v_sqrt_f32 v21, v21
  s_nop 0
  v_cvt_pk_bf16_f32 v21, v21, v21
  v_lshlrev_b32 v21, 16, v21
  v_rcp_f32 v31, v21
  s_nop 0
  v_fma_f32 v30, -v21, v31, 1.0
  v_fma_f32 v31, v30, v31, v31
  v_sub_f32 v22, v8, v20
  v_cvt_pk_bf16_f32 v22, v22, v22
  v_lshlrev_b32 v22, 16, v22
  v_mul_f32 v22, v22, v31
  v_sub_f32 v23, v9, v20
  v_cvt_pk_bf16_f32 v23, v23, v23
  v_lshlrev_b32 v23, 16, v23
  v_mul_f32 v23, v23, v31
  v_sub_f32 v24, v10, v20
  v_cvt_pk_bf16_f32 v24, v24, v24
  v_lshlrev_b32 v24, 16, v24
  v_mul_f32 v24, v24, v31
  v_sub_f32 v25, v11, v20
  v_cvt_pk_bf16_f32 v25, v25, v25
  v_lshlrev_b32 v25, 16, v25
  v_mul_f32 v25, v25, v31
  v_sub_f32 v26, v12, v20
  v_cvt_pk_bf16_f32 v26, v26, v26
  v_lshlrev_b32 v26, 16, v26
  v_mul_f32 v26, v26, v31
  v_sub_f32 v27, v13, v20
  v_cvt_pk_bf16_f32 v27, v27, v27
  v_lshlrev_b32 v27, 16, v27
  v_mul_f32 v27, v27, v31
  v_sub_f32 v28, v14, v20
  v_cvt_pk_bf16_f32 v28, v28, v28
  v_lshlrev_b32 v28, 16, v28
  v_mul_f32 v28, v28, v31
  v_sub_f32 v29, v15, v20
  v_cvt_pk_bf16_f32 v29, v29, v29
  v_lshlrev_b32 v29, 16, v29
  v_mul_f32 v29, v29, v31
  v_cvt_pk_bf16_f32 v4, v22, v23
  v_cvt_pk_bf16_f32 v5, v24, v25
  v_cvt_pk_bf16_f32 v6, v26, v27
  v_cvt_pk_bf16_f32 v7, v28, v29
  buffer_store_dwordx4 v[4:7], v3, s[4:7], s18 offen
  .Lln_kernel_end1:
  s_endpgm

.globl g1_kernel
.p2align 8
.type g1_kernel,@function
g1_kernel:
  s_cmp_ge_u32 s2, 80
  s_cbranch_scc1 .Lg1_kernel_end1
  s_load_dwordx2 s[4:5], s[0:1], 112
  s_lshr_b32 s16, s2, 4
  s_and_b32 s17, s2, 15
  s_waitcnt lgkmcnt(0)
  s_and_b32 s5, s5, 0xffff
  s_mov_b32 s6, 0x10000000
  s_mov_b32 s7, 0x00020000
  v_and_b32 v1, 63, v0
  v_lshrrev_b32 v2, 6, v0
  v_and_b32 v3, 31, v0
  v_bfe_u32 v4, v0, 5, 1
  v_lshrrev_b32 v5, 3, v0
  v_and_b32 v6, 7, v0
  s_mul_i32 s18, s17, 131072
  s_add_u32 s18, s18, 0x1310000
  s_mul_i32 s19, s16, 131072
  s_add_u32 s19, s19, 0x0
  s_mov_b32 s20, 1024
  v_mul_lo_u32 v7, v5, s20
  v_lshl_add_u32 v7, v6, 4, v7
  v_add_u32 v8, s18, v7
  v_add_u32 v9, s18, v7
  v_add_u32 v9, 0x8000, v9
  v_add_u32 v10, s18, v7
  v_add_u32 v10, 0x10000, v10
  v_add_u32 v11, s18, v7
  v_add_u32 v11, 0x18000, v11
  v_add_u32 v12, s19, v7
  v_add_u32 v13, s19, v7
  v_add_u32 v13, 0x8000, v13
  v_add_u32 v14, s19, v7
  v_add_u32 v14, 0x10000, v14
  v_add_u32 v15, s19, v7
  v_add_u32 v15, 0x18000, v15
  s_movk_i32 s21, 144
  v_mul_lo_u32 v16, v5, s21
  v_lshl_add_u32 v16, v6, 4, v16
  v_lshrrev_b32 v7, 1, v2
  v_mul_u32_u24 v7, 64, v7
  v_add_u32 v7, v7, v3
  v_mul_lo_u32 v17, v7, s21
  v_lshl_add_u32 v17, v4, 4, v17
  v_and_b32 v7, 1, v2
  v_mul_u32_u24 v7, 64, v7
  v_add_u32 v7, v7, v3
  v_mul_lo_u32 v18, v7, s21
  v_lshl_add_u32 v18, v4, 4, v18
  v_add_u32 v18, 18432, v18
  v_add_u32 v19, 36864, v16
  v_add_u32 v20, 36864, v17
  v_add_u32 v21, 36864, v18
  v_mov_b32 v120, 0
  v_mov_b32 v121, 0
  v_mov_b32 v122, 0
  v_mov_b32 v123, 0
  v_mov_b32 v124, 0
  v_mov_b32 v125, 0
  v_mov_b32 v126, 0
  v_mov_b32 v127, 0
  v_mov_b32 v128, 0
  v_mov_b32 v129, 0
  v_mov_b32 v130, 0
  v_mov_b32 v131, 0
  v_mov_b32 v132, 0
  v_mov_b32 v133, 0
  v_mov_b32 v134, 0
  v_mov_b32 v135, 0
  v_mov_b32 v136, 0
  v_mov_b32 v137, 0
  v_mov_b32 v138, 0
  v_mov_b32 v139, 0
  v_mov_b32 v140, 0
  v_mov_b32 v141, 0
  v_mov_b32 v142, 0
  v_mov_b32 v143, 0
  v_mov_b32 v144, 0
  v_mov_b32 v145, 0
  v_mov_b32 v146, 0
  v_mov_b32 v147, 0
  v_mov_b32 v148, 0
  v_mov_b32 v149, 0
  v_mov_b32 v150, 0
  v_mov_b32 v151, 0
  v_mov_b32 v152, 0
  v_mov_b32 v153, 0
  v_mov_b32 v154, 0
  v_mov_b32 v155, 0
  v_mov_b32 v156, 0
  v_mov_b32 v157, 0
  v_mov_b32 v158, 0
  v_mov_b32 v159, 0
  v_mov_b32 v160, 0
  v_mov_b32 v161, 0
  v_mov_b32 v162, 0
  v_mov_b32 v163, 0
  v_mov_b32 v164, 0
  v_mov_b32 v165, 0
  v_mov_b32 v166, 0
  v_mov_b32 v167, 0
  v_mov_b32 v168, 0
  v_mov_b32 v169, 0
  v_mov_b32 v170, 0
  v_mov_b32 v171, 0
  v_mov_b32 v172, 0
  v_mov_b32 v173, 0
  v_mov_b32 v174, 0
  v_mov_b32 v175, 0
  v_mov_b32 v176, 0
  v_mov_b32 v177, 0
  v_mov_b32 v178, 0
  v_mov_b32 v179, 0
  v_mov_b32 v180, 0
  v_mov_b32 v181, 0
  v_mov_b32 v182, 0
  v_mov_b32 v183, 0
  s_mov_b32 s18, 0
  buffer_load_dwordx4 v[24:27], v8, s[4:7], s18 offen
  buffer_load_dwordx4 v[28:31], v9, s[4:7], s18 offen
  buffer_load_dwordx4 v[32:35], v10, s[4:7], s18 offen
  buffer_load_dwordx4 v[36:39], v11, s[4:7], s18 offen
  buffer_load_dwordx4 v[40:43], v12, s[4:7], s18 offen
  buffer_load_dwordx4 v[44:47], v13, s[4:7], s18 offen
  buffer_load_dwordx4 v[48:51], v14, s[4:7], s18 offen
  buffer_load_dwordx4 v[52:55], v15, s[4:7], s18 offen
  s_movk_i32 s18, 128
  buffer_load_dwordx4 v[56:59], v8, s[4:7], s18 offen
  buffer_load_dwordx4 v[60:63], v9, s[4:7], s18 offen
  buffer_load_dwordx4 v[64:67], v10, s[4:7], s18 offen
  buffer_load_dwordx4 v[68:71], v11, s[4:7], s18 offen
  buffer_load_dwordx4 v[72:75], v12, s[4:7], s18 offen
  buffer_load_dwordx4 v[76:79], v13, s[4:7], s18 offen
  buffer_load_dwordx4 v[80:83], v14, s[4:7], s18 offen
  buffer_load_dwordx4 v[84:87], v15, s[4:7], s18 offen
  s_waitcnt vmcnt(8)
  ds_write_b128 v16, v[24:27] offset:0
  ds_write_b128 v16, v[28:31] offset:4608
  ds_write_b128 v16, v[32:35] offset:9216
  ds_write_b128 v16, v[36:39] offset:13824
  ds_write_b128 v16, v[40:43] offset:18432
  ds_write_b128 v16, v[44:47] offset:23040
  ds_write_b128 v16, v[48:51] offset:27648
  ds_write_b128 v16, v[52:55] offset:32256
  s_waitcnt lgkmcnt(0)
  s_barrier
  s_mov_b32 s22, 0
  .Lg1_kernel_loop2:
  s_add_u32 s18, s18, 128
  s_cmp_lt_u32 s22, 6
  s_cbranch_scc0 .Lg1_kernel_skl3
  buffer_load_dwordx4 v[24:27], v8, s[4:7], s18 offen
  buffer_load_dwordx4 v[28:31], v9, s[4:7], s18 offen
  buffer_load_dwordx4 v[32:35], v10, s[4:7], s18 offen
  buffer_load_dwordx4 v[36:39], v11, s[4:7], s18 offen
  buffer_load_dwordx4 v[40:43], v12, s[4:7], s18 offen
  buffer_load_dwordx4 v[44:47], v13, s[4:7], s18 offen
  buffer_load_dwordx4 v[48:51], v14, s[4:7], s18 offen
  buffer_load_dwordx4 v[52:55], v15, s[4:7], s18 offen
  .Lg1_kernel_skl3:
  ds_read_b128 v[88:91], v17 offset:0
  ds_read_b128 v[92:95], v17 offset:4608
  ds_read_b128 v[96:99], v18 offset:0
  ds_read_b128 v[100:103], v18 offset:4608
  ds_read_b128 v[104:107], v17 offset:32
  ds_read_b128 v[108:111], v17 offset:4640
  ds_read_b128 v[112:115], v18 offset:32
  ds_read_b128 v[116:119], v18 offset:4640
  s_waitcnt lgkmcnt(4)
  v_mfma_f32_32x32x16_bf16 v[120:135], v[96:99], v[88:91], v[120:135]
  v_mfma_f32_32x32x16_bf16 v[136:151], v[96:99], v[92:95], v[136:151]
  v_mfma_f32_32x32x16_bf16 v[152:167], v[100:103], v[88:91], v[152:167]
  v_mfma_f32_32x32x16_bf16 v[168:183], v[100:103], v[92:95], v[168:183]
  ds_read_b128 v[88:91], v17 offset:64
  ds_read_b128 v[92:95], v17 offset:4672
  ds_read_b128 v[96:99], v18 offset:64
  ds_read_b128 v[100:103], v18 offset:4672
  s_waitcnt lgkmcnt(4)
  v_mfma_f32_32x32x16_bf16 v[120:135], v[112:115], v[104:107], v[120:135]
  v_mfma_f32_32x32x16_bf16 v[136:151], v[112:115], v[108:111], v[136:151]
  v_mfma_f32_32x32x16_bf16 v[152:167], v[116:119], v[104:107], v[152:167]
  v_mfma_f32_32x32x16_bf16 v[168:183], v[116:119], v[108:111], v[168:183]
  ds_read_b128 v[104:107], v17 offset:96
  ds_read_b128 v[108:111], v17 offset:4704
  ds_read_b128 v[112:115], v18 offset:96
  ds_read_b128 v[116:119], v18 offset:4704
  s_waitcnt lgkmcnt(4)
  v_mfma_f32_32x32x16_bf16 v[120:135], v[96:99], v[88:91], v[120:135]
  v_mfma_f32_32x32x16_bf16 v[136:151], v[96:99], v[92:95], v[136:151]
  v_mfma_f32_32x32x16_bf16 v[152:167], v[100:103], v[88:91], v[152:167]
  v_mfma_f32_32x32x16_bf16 v[168:183], v[100:103], v[92:95], v[168:183]
  s_waitcnt lgkmcnt(0)
  v_mfma_f32_32x32x16_bf16 v[120:135], v[112:115], v[104:107], v[120:135]
  v_mfma_f32_32x32x16_bf16 v[136:151], v[112:115], v[108:111], v[136:151]
  v_mfma_f32_32x32x16_bf16 v[152:167], v[116:119], v[104:107], v[152:167]
  v_mfma_f32_32x32x16_bf16 v[168:183], v[116:119], v[108:111], v[168:183]
  s_cmp_lt_u32 s22, 7
  s_cbranch_scc0 .Lg1_kernel_sks4
  s_cmp_lt_u32 s22, 6
  s_cbranch_scc0 .Lg1_kernel_skw5
  s_waitcnt vmcnt(8)
  .Lg1_kernel_skw5:
  s_cmp_lt_u32 s22, 6
  s_cbranch_scc1 .Lg1_kernel_skv6
  s_waitcnt vmcnt(0)
  .Lg1_kernel_skv6:
  ds_write_b128 v19, v[56:59] offset:0
  ds_write_b128 v19, v[60:63] offset:4608
  ds_write_b128 v19, v[64:67] offset:9216
  ds_write_b128 v19, v[68:71] offset:13824
  ds_write_b128 v19, v[72:75] offset:18432
  ds_write_b128 v19, v[76:79] offset:23040
  ds_write_b128 v19, v[80:83] offset:27648
  ds_write_b128 v19, v[84:87] offset:32256
  .Lg1_kernel_sks4:
  s_waitcnt lgkmcnt(0)
  s_barrier
  s_add_u32 s18, s18, 128
  s_cmp_lt_u32 s22, 5
  s_cbranch_scc0 .Lg1_kernel_skl7
  buffer_load_dwordx4 v[56:59], v8, s[4:7], s18 offen
  buffer_load_dwordx4 v[60:63], v9, s[4:7], s18 offen
  buffer_load_dwordx4 v[64:67], v10, s[4:7], s18 offen
  buffer_load_dwordx4 v[68:71], v11, s[4:7], s18 offen
  buffer_load_dwordx4 v[72:75], v12, s[4:7], s18 offen
  buffer_load_dwordx4 v[76:79], v13, s[4:7], s18 offen
  buffer_load_dwordx4 v[80:83], v14, s[4:7], s18 offen
  buffer_load_dwordx4 v[84:87], v15, s[4:7], s18 offen
  .Lg1_kernel_skl7:
  ds_read_b128 v[88:91], v20 offset:0
  ds_read_b128 v[92:95], v20 offset:4608
  ds_read_b128 v[96:99], v21 offset:0
  ds_read_b128 v[100:103], v21 offset:4608
  ds_read_b128 v[104:107], v20 offset:32
  ds_read_b128 v[108:111], v20 offset:4640
  ds_read_b128 v[112:115], v21 offset:32
  ds_read_b128 v[116:119], v21 offset:4640
  s_waitcnt lgkmcnt(4)
  v_mfma_f32_32x32x16_bf16 v[120:135], v[96:99], v[88:91], v[120:135]
  v_mfma_f32_32x32x16_bf16 v[136:151], v[96:99], v[92:95], v[136:151]
  v_mfma_f32_32x32x16_bf16 v[152:167], v[100:103], v[88:91], v[152:167]
  v_mfma_f32_32x32x16_bf16 v[168:183], v[100:103], v[92:95], v[168:183]
  ds_read_b128 v[88:91], v20 offset:64
  ds_read_b128 v[92:95], v20 offset:4672
  ds_read_b128 v[96:99], v21 offset:64
  ds_read_b128 v[100:103], v21 offset:4672
  s_waitcnt lgkmcnt(4)
  v_mfma_f32_32x32x16_bf16 v[120:135], v[112:115], v[104:107], v[120:135]
  v_mfma_f32_32x32x16_bf16 v[136:151], v[112:115], v[108:111], v[136:151]
  v_mfma_f32_32x32x16_bf16 v[152:167], v[116:119], v[104:107], v[152:167]
  v_mfma_f32_32x32x16_bf16 v[168:183], v[116:119], v[108:111], v[168:183]
  ds_read_b128 v[104:107], v20 offset:96
  ds_read_b128 v[108:111], v20 offset:4704
  ds_read_b128 v[112:115], v21 offset:96
  ds_read_b128 v[116:119], v21 offset:4704
  s_waitcnt lgkmcnt(4)
  v_mfma_f32_32x32x16_bf16 v[120:135], v[96:99], v[88:91], v[120:135]
  v_mfma_f32_32x32x16_bf16 v[136:151], v[96:99], v[92:95], v[136:151]
  v_mfma_f32_32x32x16_bf16 v[152:167], v[100:103], v[88:91], v[152:167]
  v_mfma_f32_32x32x16_bf16 v[168:183], v[100:103], v[92:95], v[168:183]
  s_waitcnt lgkmcnt(0)
  v_mfma_f32_32x32x16_bf16 v[120:135], v[112:115], v[104:107], v[120:135]
  v_mfma_f32_32x32x16_bf16 v[136:151], v[112:115], v[108:111], v[136:151]
  v_mfma_f32_32x32x16_bf16 v[152:167], v[116:119], v[104:107], v[152:167]
  v_mfma_f32_32x32x16_bf16 v[168:183], v[116:119], v[108:111], v[168:183]
  s_cmp_lt_u32 s22, 6
  s_cbranch_scc0 .Lg1_kernel_sks8
  s_cmp_lt_u32 s22, 5
  s_cbranch_scc0 .Lg1_kernel_skw9
  s_waitcnt vmcnt(8)
  .Lg1_kernel_skw9:
  s_cmp_lt_u32 s22, 5
  s_cbranch_scc1 .Lg1_kernel_skv10
  s_waitcnt vmcnt(0)
  .Lg1_kernel_skv10:
  ds_write_b128 v16, v[24:27] offset:0
  ds_write_b128 v16, v[28:31] offset:4608
  ds_write_b128 v16, v[32:35] offset:9216
  ds_write_b128 v16, v[36:39] offset:13824
  ds_write_b128 v16, v[40:43] offset:18432
  ds_write_b128 v16, v[44:47] offset:23040
  ds_write_b128 v16, v[48:51] offset:27648
  ds_write_b128 v16, v[52:55] offset:32256
  .Lg1_kernel_sks8:
  s_waitcnt lgkmcnt(0)
  s_barrier
  s_add_u32 s22, s22, 2
  s_cmp_lt_u32 s22, 8
  s_cbranch_scc1 .Lg1_kernel_loop2
  s_nop 15
  v_lshrrev_b32 v184, 1, v2
  v_and_b32 v185, 1, v2
  s_lshl_b32 s24, s17, 7
  v_lshlrev_b32 v186, 6, v184
  v_add3_u32 v186, v186, v3, s24
  s_cmp_eq_u32 s16, 4
  s_cbranch_scc1 .Lg1_kernel_kv11
  v_lshlrev_b32 v187, 10, v186
  s_lshl_b32 s25, s16, 8
  v_lshl_add_u32 v187, v185, 7, v187
  v_lshl_add_u32 v187, v4, 3, v187
  v_add_u32 v187, s25, v187
  s_mov_b32 s26, 0x1510000
  s_add_u32 s27, s26, 0x8000
  v_cvt_pk_bf16_f32 v188, v120, v121
  v_cvt_pk_bf16_f32 v189, v122, v123
  buffer_store_dwordx2 v[188:189], v187, s[4:7], s26 offen offset:0
  s_nop 0
  v_cvt_pk_bf16_f32 v188, v124, v125
  v_cvt_pk_bf16_f32 v189, v126, v127
  buffer_store_dwordx2 v[188:189], v187, s[4:7], s26 offen offset:16
  s_nop 0
  v_cvt_pk_bf16_f32 v188, v128, v129
  v_cvt_pk_bf16_f32 v189, v130, v131
  buffer_store_dwordx2 v[188:189], v187, s[4:7], s26 offen offset:32
  s_nop 0
  v_cvt_pk_bf16_f32 v188, v132, v133
  v_cvt_pk_bf16_f32 v189, v134, v135
  buffer_store_dwordx2 v[188:189], v187, s[4:7], s26 offen offset:48
  s_nop 0
  v_cvt_pk_bf16_f32 v188, v136, v137
  v_cvt_pk_bf16_f32 v189, v138, v139
  buffer_store_dwordx2 v[188:189], v187, s[4:7], s27 offen offset:0
  s_nop 0
  v_cvt_pk_bf16_f32 v188, v140, v141
  v_cvt_pk_bf16_f32 v189, v142, v143
  buffer_store_dwordx2 v[188:189], v187, s[4:7], s27 offen offset:16
  s_nop 0
  v_cvt_pk_bf16_f32 v188, v144, v145
  v_cvt_pk_bf16_f32 v189, v146, v147
  buffer_store_dwordx2 v[188:189], v187, s[4:7], s27 offen offset:32
  s_nop 0
  v_cvt_pk_bf16_f32 v188, v148, v149
  v_cvt_pk_bf16_f32 v189, v150, v151
  buffer_store_dwordx2 v[188:189], v187, s[4:7], s27 offen offset:48
  s_nop 0
  v_cvt_pk_bf16_f32 v188, v152, v153
  v_cvt_pk_bf16_f32 v189, v154, v155
  buffer_store_dwordx2 v[188:189], v187, s[4:7], s26 offen offset:64
  s_nop 0
  v_cvt_pk_bf16_f32 v188, v156, v157
  v_cvt_pk_bf16_f32 v189, v158, v159
  buffer_store_dwordx2 v[188:189], v187, s[4:7], s26 offen offset:80
  s_nop 0
  v_cvt_pk_bf16_f32 v188, v160, v161
  v_cvt_pk_bf16_f32 v189, v162, v163
  buffer_store_dwordx2 v[188:189], v187, s[4:7], s26 offen offset:96
  s_nop 0
  v_cvt_pk_bf16_f32 v188, v164, v165
  v_cvt_pk_bf16_f32 v189, v166, v167
  buffer_store_dwordx2 v[188:189], v187, s[4:7], s26 offen offset:112
  s_nop 0
  v_cvt_pk_bf16_f32 v188, v168, v169
  v_cvt_pk_bf16_f32 v189, v170, v171
  buffer_store_dwordx2 v[188:189], v187, s[4:7], s27 offen offset:64
  s_nop 0
  v_cvt_pk_bf16_f32 v188, v172, v173
  v_cvt_pk_bf16_f32 v189, v174, v175
  buffer_store_dwordx2 v[188:189], v187, s[4:7], s27 offen offset:80
  s_nop 0
  v_cvt_pk_bf16_f32 v188, v176, v177
  v_cvt_pk_bf16_f32 v189, v178, v179
  buffer_store_dwordx2 v[188:189], v187, s[4:7], s27 offen offset:96
  s_nop 0
  v_cvt_pk_bf16_f32 v188, v180, v181
  v_cvt_pk_bf16_f32 v189, v182, v183
  buffer_store_dwordx2 v[188:189], v187, s[4:7], s27 offen offset:112
  s_nop 0
  s_branch .Lg1_kernel_qend12
  .Lg1_kernel_kv11:
  v_readfirstlane_b32 s25, v185
  s_nop 3
  s_cmp_eq_u32 s25, 0
  s_cbranch_scc0 .Lg1_kernel_qend12
  v_lshlrev_b32 v187, 5, v186
  v_lshl_add_u32 v187, v4, 3, v187
  s_mov_b32 s26, 0x1710000
  s_add_u32 s27, s26, 0x400
  v_lshlrev_b32 v190, 1, v186
  v_lshl_add_u32 v190, v4, 14, v190
  s_mov_b32 s28, 0x1720000
  s_add_u32 s29, s28, 64
  v_cvt_pk_bf16_f32 v188, v120, v121
  v_cvt_pk_bf16_f32 v189, v122, v123
  buffer_store_dwordx2 v[188:189], v187, s[4:7], s26 offen offset:0
  s_nop 0
  v_cvt_pk_bf16_f32 v188, v124, v125
  v_cvt_pk_bf16_f32 v189, v126, v127
  buffer_store_dwordx2 v[188:189], v187, s[4:7], s26 offen offset:16
  s_nop 0
  v_cvt_pk_bf16_f32 v188, v128, v128
  v_add_u32 v191, 0x0, v190
  buffer_store_short v188, v191, s[4:7], s28 offen
  v_cvt_pk_bf16_f32 v188, v129, v129
  v_add_u32 v191, 0x1000, v190
  buffer_store_short v188, v191, s[4:7], s28 offen
  v_cvt_pk_bf16_f32 v188, v130, v130
  v_add_u32 v191, 0x2000, v190
  buffer_store_short v188, v191, s[4:7], s28 offen
  v_cvt_pk_bf16_f32 v188, v131, v131
  v_add_u32 v191, 0x3000, v190
  buffer_store_short v188, v191, s[4:7], s28 offen
  v_cvt_pk_bf16_f32 v188, v132, v132
  v_add_u32 v191, 0x8000, v190
  buffer_store_short v188, v191, s[4:7], s28 offen
  v_cvt_pk_bf16_f32 v188, v133, v133
  v_add_u32 v191, 0x9000, v190
  buffer_store_short v188, v191, s[4:7], s28 offen
  v_cvt_pk_bf16_f32 v188, v134, v134
  v_add_u32 v191, 0xa000, v190
  buffer_store_short v188, v191, s[4:7], s28 offen
  v_cvt_pk_bf16_f32 v188, v135, v135
  v_add_u32 v191, 0xb000, v190
  buffer_store_short v188, v191, s[4:7], s28 offen
  v_cvt_pk_bf16_f32 v188, v136, v137
  v_cvt_pk_bf16_f32 v189, v138, v139
  buffer_store_dwordx2 v[188:189], v187, s[4:7], s27 offen offset:0
  s_nop 0
  v_cvt_pk_bf16_f32 v188, v140, v141
  v_cvt_pk_bf16_f32 v189, v142, v143
  buffer_store_dwordx2 v[188:189], v187, s[4:7], s27 offen offset:16
  s_nop 0
  v_cvt_pk_bf16_f32 v188, v144, v144
  v_add_u32 v191, 0x0, v190
  buffer_store_short v188, v191, s[4:7], s29 offen
  v_cvt_pk_bf16_f32 v188, v145, v145
  v_add_u32 v191, 0x1000, v190
  buffer_store_short v188, v191, s[4:7], s29 offen
  v_cvt_pk_bf16_f32 v188, v146, v146
  v_add_u32 v191, 0x2000, v190
  buffer_store_short v188, v191, s[4:7], s29 offen
  v_cvt_pk_bf16_f32 v188, v147, v147
  v_add_u32 v191, 0x3000, v190
  buffer_store_short v188, v191, s[4:7], s29 offen
  v_cvt_pk_bf16_f32 v188, v148, v148
  v_add_u32 v191, 0x8000, v190
  buffer_store_short v188, v191, s[4:7], s29 offen
  v_cvt_pk_bf16_f32 v188, v149, v149
  v_add_u32 v191, 0x9000, v190
  buffer_store_short v188, v191, s[4:7], s29 offen
  v_cvt_pk_bf16_f32 v188, v150, v150
  v_add_u32 v191, 0xa000, v190
  buffer_store_short v188, v191, s[4:7], s29 offen
  v_cvt_pk_bf16_f32 v188, v151, v151
  v_add_u32 v191, 0xb000, v190
  buffer_store_short v188, v191, s[4:7], s29 offen
  .Lg1_kernel_qend12:
  .Lg1_kernel_end1:
  s_endpgm

.globl g2_kernel
.p2align 8
.type g2_kernel,@function
g2_kernel:
  s_cmp_ge_u32 s2, 256
  s_cbranch_scc1 .Lg2_kernel_end1
  s_load_dwordx2 s[4:5], s[0:1], 112
  s_load_dwordx2 s[12:13], s[0:1], 96
  s_lshr_b32 s16, s2, 5
  s_lshr_b32 s17, s2, 3
  s_and_b32 s17, s17, 3
  s_lshl_b32 s17, s17, 3
  s_and_b32 s24, s2, 7
  s_add_u32 s17, s17, s24
  s_waitcnt lgkmcnt(0)
  s_and_b32 s5, s5, 0xffff
  s_mov_b32 s6, 0x10000000
  s_mov_b32 s7, 0x00020000
  s_and_b32 s13, s13, 0xffff
  s_mov_b32 s14, 0x200000
  s_mov_b32 s15, 0x00020000
  v_and_b32 v1, 63, v0
  v_lshrrev_b32 v2, 6, v0
  v_and_b32 v3, 31, v0
  v_bfe_u32 v4, v0, 5, 1
  v_lshrrev_b32 v5, 3, v0
  v_and_b32 v6, 7, v0
  s_mul_i32 s18, s17, 65536
  s_add_u32 s18, s18, 0x1730000
  s_mul_i32 s19, s16, 65536
  s_add_u32 s19, s19, 0x90000
  s_mov_b32 s20, 1024
  v_mul_lo_u32 v7, v5, s20
  v_lshl_add_u32 v7, v6, 4, v7
  v_add_u32 v8, s18, v7
  v_add_u32 v9, s18, v7
  v_add_u32 v9, 0x8000, v9
  v_add_u32 v10, s19, v7
  v_add_u32 v11, s19, v7
  v_add_u32 v11, 0x8000, v11
  s_movk_i32 s21, 144
  v_mul_lo_u32 v12, v5, s21
  v_lshl_add_u32 v12, v6, 4, v12
  v_lshrrev_b32 v7, 1, v2
  v_mul_u32_u24 v7, 32, v7
  v_add_u32 v7, v7, v3
  v_mul_lo_u32 v13, v7, s21
  v_lshl_add_u32 v13, v4, 4, v13
  v_and_b32 v7, 1, v2
  v_mul_u32_u24 v7, 32, v7
  v_add_u32 v7, v7, v3
  v_mul_lo_u32 v14, v7, s21
  v_lshl_add_u32 v14, v4, 4, v14
  v_add_u32 v14, 9216, v14
  v_add_u32 v15, 18432, v12
  v_add_u32 v16, 18432, v13
  v_add_u32 v17, 18432, v14
  v_mov_b32 v68, 0
  v_mov_b32 v69, 0
  v_mov_b32 v70, 0
  v_mov_b32 v71, 0
  v_mov_b32 v72, 0
  v_mov_b32 v73, 0
  v_mov_b32 v74, 0
  v_mov_b32 v75, 0
  v_mov_b32 v76, 0
  v_mov_b32 v77, 0
  v_mov_b32 v78, 0
  v_mov_b32 v79, 0
  v_mov_b32 v80, 0
  v_mov_b32 v81, 0
  v_mov_b32 v82, 0
  v_mov_b32 v83, 0
  s_mov_b32 s18, 0
  buffer_load_dwordx4 v[20:23], v8, s[4:7], s18 offen
  buffer_load_dwordx4 v[24:27], v9, s[4:7], s18 offen
  buffer_load_dwordx4 v[28:31], v10, s[4:7], s18 offen
  buffer_load_dwordx4 v[32:35], v11, s[4:7], s18 offen
  s_movk_i32 s18, 128
  buffer_load_dwordx4 v[36:39], v8, s[4:7], s18 offen
  buffer_load_dwordx4 v[40:43], v9, s[4:7], s18 offen
  buffer_load_dwordx4 v[44:47], v10, s[4:7], s18 offen
  buffer_load_dwordx4 v[48:51], v11, s[4:7], s18 offen
  s_waitcnt vmcnt(4)
  ds_write_b128 v12, v[20:23] offset:0
  ds_write_b128 v12, v[24:27] offset:4608
  ds_write_b128 v12, v[28:31] offset:9216
  ds_write_b128 v12, v[32:35] offset:13824
  s_waitcnt lgkmcnt(0)
  s_barrier
  s_mov_b32 s22, 0
  .Lg2_kernel_loop2:
  s_add_u32 s18, s18, 128
  s_cmp_lt_u32 s22, 6
  s_cbranch_scc0 .Lg2_kernel_skl3
  buffer_load_dwordx4 v[20:23], v8, s[4:7], s18 offen
  buffer_load_dwordx4 v[24:27], v9, s[4:7], s18 offen
  buffer_load_dwordx4 v[28:31], v10, s[4:7], s18 offen
  buffer_load_dwordx4 v[32:35], v11, s[4:7], s18 offen
  .Lg2_kernel_skl3:
  ds_read_b128 v[52:55], v13 offset:0
  ds_read_b128 v[56:59], v14 offset:0
  ds_read_b128 v[60:63], v13 offset:32
  ds_read_b128 v[64:67], v14 offset:32
  s_waitcnt lgkmcnt(2)
  v_mfma_f32_32x32x16_bf16 v[68:83], v[56:59], v[52:55], v[68:83]
  ds_read_b128 v[52:55], v13 offset:64
  ds_read_b128 v[56:59], v14 offset:64
  s_waitcnt lgkmcnt(2)
  v_mfma_f32_32x32x16_bf16 v[68:83], v[64:67], v[60:63], v[68:83]
  ds_read_b128 v[60:63], v13 offset:96
  ds_read_b128 v[64:67], v14 offset:96
  s_waitcnt lgkmcnt(2)
  v_mfma_f32_32x32x16_bf16 v[68:83], v[56:59], v[52:55], v[68:83]
  s_waitcnt lgkmcnt(0)
  v_mfma_f32_32x32x16_bf16 v[68:83], v[64:67], v[60:63], v[68:83]
  s_cmp_lt_u32 s22, 7
  s_cbranch_scc0 .Lg2_kernel_sks4
  s_cmp_lt_u32 s22, 6
  s_cbranch_scc0 .Lg2_kernel_skw5
  s_waitcnt vmcnt(4)
  .Lg2_kernel_skw5:
  s_cmp_lt_u32 s22, 6
  s_cbranch_scc1 .Lg2_kernel_skv6
  s_waitcnt vmcnt(0)
  .Lg2_kernel_skv6:
  ds_write_b128 v15, v[36:39] offset:0
  ds_write_b128 v15, v[40:43] offset:4608
  ds_write_b128 v15, v[44:47] offset:9216
  ds_write_b128 v15, v[48:51] offset:13824
  .Lg2_kernel_sks4:
  s_waitcnt lgkmcnt(0)
  s_barrier
  s_add_u32 s18, s18, 128
  s_cmp_lt_u32 s22, 5
  s_cbranch_scc0 .Lg2_kernel_skl7
  buffer_load_dwordx4 v[36:39], v8, s[4:7], s18 offen
  buffer_load_dwordx4 v[40:43], v9, s[4:7], s18 offen
  buffer_load_dwordx4 v[44:47], v10, s[4:7], s18 offen
  buffer_load_dwordx4 v[48:51], v11, s[4:7], s18 offen
  .Lg2_kernel_skl7:
  ds_read_b128 v[52:55], v16 offset:0
  ds_read_b128 v[56:59], v17 offset:0
  ds_read_b128 v[60:63], v16 offset:32
  ds_read_b128 v[64:67], v17 offset:32
  s_waitcnt lgkmcnt(2)
  v_mfma_f32_32x32x16_bf16 v[68:83], v[56:59], v[52:55], v[68:83]
  ds_read_b128 v[52:55], v16 offset:64
  ds_read_b128 v[56:59], v17 offset:64
  s_waitcnt lgkmcnt(2)
  v_mfma_f32_32x32x16_bf16 v[68:83], v[64:67], v[60:63], v[68:83]
  ds_read_b128 v[60:63], v16 offset:96
  ds_read_b128 v[64:67], v17 offset:96
  s_waitcnt lgkmcnt(2)
  v_mfma_f32_32x32x16_bf16 v[68:83], v[56:59], v[52:55], v[68:83]
  s_waitcnt lgkmcnt(0)
  v_mfma_f32_32x32x16_bf16 v[68:83], v[64:67], v[60:63], v[68:83]
  s_cmp_lt_u32 s22, 6
  s_cbranch_scc0 .Lg2_kernel_sks8
  s_cmp_lt_u32 s22, 5
  s_cbranch_scc0 .Lg2_kernel_skw9
  s_waitcnt vmcnt(4)
  .Lg2_kernel_skw9:
  s_cmp_lt_u32 s22, 5
  s_cbranch_scc1 .Lg2_kernel_skv10
  s_waitcnt vmcnt(0)
  .Lg2_kernel_skv10:
  ds_write_b128 v12, v[20:23] offset:0
  ds_write_b128 v12, v[24:27] offset:4608
  ds_write_b128 v12, v[28:31] offset:9216
  ds_write_b128 v12, v[32:35] offset:13824
  .Lg2_kernel_sks8:
  s_waitcnt lgkmcnt(0)
  s_barrier
  s_add_u32 s22, s22, 2
  s_cmp_lt_u32 s22, 8
  s_cbranch_scc1 .Lg2_kernel_loop2
  s_nop 15
  v_lshrrev_b32 v84, 1, v2
  v_and_b32 v85, 1, v2
  s_mul_i32 s24, s17, 64
  v_mul_u32_u24 v86, 32, v84
  v_add3_u32 v86, v86, v3, s24
  v_lshlrev_b32 v86, 10, v86
  s_mul_i32 s25, s16, 128
  v_mul_u32_u24 v87, 64, v85
  v_add3_u32 v86, v86, v87, s25
  v_lshl_add_u32 v86, v4, 3, v86
  s_mov_b32 s26, 0x1110000
  s_add_u32 s27, s26, 0x8000
  s_movk_i32 s28, 0
  s_mov_b32 s29, 0x8000
  buffer_load_dwordx2 v[20:21], v86, s[4:7], s26 offen offset:0
  buffer_load_dwordx2 v[22:23], v86, s[4:7], s26 offen offset:16
  buffer_load_dwordx2 v[24:25], v86, s[4:7], s26 offen offset:32
  buffer_load_dwordx2 v[26:27], v86, s[4:7], s26 offen offset:48
  s_waitcnt vmcnt(3)
  v_cvt_pk_bf16_f32 v68, v68, v68
  v_lshlrev_b32 v68, 16, v68
  v_cvt_pk_bf16_f32 v69, v69, v69
  v_lshlrev_b32 v69, 16, v69
  v_cvt_pk_bf16_f32 v70, v70, v70
  v_lshlrev_b32 v70, 16, v70
  v_cvt_pk_bf16_f32 v71, v71, v71
  v_lshlrev_b32 v71, 16, v71
  v_lshlrev_b32 v88, 16, v20
  v_and_b32 v89, 0xffff0000, v20
  v_lshlrev_b32 v90, 16, v21
  v_and_b32 v91, 0xffff0000, v21
  v_add_f32 v88, v88, v68
  v_add_f32 v89, v89, v69
  v_add_f32 v90, v90, v70
  v_add_f32 v91, v91, v71
  v_cvt_pk_bf16_f32 v20, v88, v89
  v_cvt_pk_bf16_f32 v21, v90, v91
  s_waitcnt vmcnt(2)
  v_cvt_pk_bf16_f32 v72, v72, v72
  v_lshlrev_b32 v72, 16, v72
  v_cvt_pk_bf16_f32 v73, v73, v73
  v_lshlrev_b32 v73, 16, v73
  v_cvt_pk_bf16_f32 v74, v74, v74
  v_lshlrev_b32 v74, 16, v74
  v_cvt_pk_bf16_f32 v75, v75, v75
  v_lshlrev_b32 v75, 16, v75
  v_lshlrev_b32 v88, 16, v22
  v_and_b32 v89, 0xffff0000, v22
  v_lshlrev_b32 v90, 16, v23
  v_and_b32 v91, 0xffff0000, v23
  v_add_f32 v88, v88, v72
  v_add_f32 v89, v89, v73
  v_add_f32 v90, v90, v74
  v_add_f32 v91, v91, v75
  v_cvt_pk_bf16_f32 v22, v88, v89
  v_cvt_pk_bf16_f32 v23, v90, v91
  s_waitcnt vmcnt(1)
  v_cvt_pk_bf16_f32 v76, v76, v76
  v_lshlrev_b32 v76, 16, v76
  v_cvt_pk_bf16_f32 v77, v77, v77
  v_lshlrev_b32 v77, 16, v77
  v_cvt_pk_bf16_f32 v78, v78, v78
  v_lshlrev_b32 v78, 16, v78
  v_cvt_pk_bf16_f32 v79, v79, v79
  v_lshlrev_b32 v79, 16, v79
  v_lshlrev_b32 v88, 16, v24
  v_and_b32 v89, 0xffff0000, v24
  v_lshlrev_b32 v90, 16, v25
  v_and_b32 v91, 0xffff0000, v25
  v_add_f32 v88, v88, v76
  v_add_f32 v89, v89, v77
  v_add_f32 v90, v90, v78
  v_add_f32 v91, v91, v79
  v_cvt_pk_bf16_f32 v24, v88, v89
  v_cvt_pk_bf16_f32 v25, v90, v91
  s_waitcnt vmcnt(0)
  v_cvt_pk_bf16_f32 v80, v80, v80
  v_lshlrev_b32 v80, 16, v80
  v_cvt_pk_bf16_f32 v81, v81, v81
  v_lshlrev_b32 v81, 16, v81
  v_cvt_pk_bf16_f32 v82, v82, v82
  v_lshlrev_b32 v82, 16, v82
  v_cvt_pk_bf16_f32 v83, v83, v83
  v_lshlrev_b32 v83, 16, v83
  v_lshlrev_b32 v88, 16, v26
  v_and_b32 v89, 0xffff0000, v26
  v_lshlrev_b32 v90, 16, v27
  v_and_b32 v91, 0xffff0000, v27
  v_add_f32 v88, v88, v80
  v_add_f32 v89, v89, v81
  v_add_f32 v90, v90, v82
  v_add_f32 v91, v91, v83
  v_cvt_pk_bf16_f32 v26, v88, v89
  v_cvt_pk_bf16_f32 v27, v90, v91
  buffer_store_dwordx2 v[20:21], v86, s[4:7], s26 offen offset:0
  buffer_store_dwordx2 v[20:21], v86, s[12:15], s28 offen offset:0
  buffer_store_dwordx2 v[22:23], v86, s[4:7], s26 offen offset:16
  buffer_store_dwordx2 v[22:23], v86, s[12:15], s28 offen offset:16
  buffer_store_dwordx2 v[24:25], v86, s[4:7], s26 offen offset:32
  buffer_store_dwordx2 v[24:25], v86, s[12:15], s28 offen offset:32
  buffer_store_dwordx2 v[26:27], v86, s[4:7], s26 offen offset:48
  buffer_store_dwordx2 v[26:27], v86, s[12:15], s28 offen offset:48
  .Lg2_kernel_end1:
  s_endpgm

.globl g3_kernel
.p2align 8
.type g3_kernel,@function
g3_kernel:
  s_cmp_ge_u32 s2, 1024
  s_cbranch_scc1 .Lg3_kernel_end1
  s_load_dwordx2 s[4:5], s[0:1], 112
  s_and_b32 s16, s2, 7
  s_lshl_b32 s16, s16, 3
  s_add_u32 s16, s16, 32
  s_lshr_b32 s17, s2, 7
  s_add_u32 s16, s16, s17
  s_lshr_b32 s17, s2, 3
  s_and_b32 s17, s17, 15
  s_waitcnt lgkmcnt(0)
  s_and_b32 s5, s5, 0xffff
  s_mov_b32 s6, 0x10000000
  s_mov_b32 s7, 0x00020000
  v_and_b32 v1, 63, v0
  v_lshrrev_b32 v2, 6, v0
  v_and_b32 v3, 31, v0
  v_bfe_u32 v4, v0, 5, 1
  v_lshrrev_b32 v5, 3, v0
  v_and_b32 v6, 7, v0
  s_mul_i32 s18, s17, 131072
  s_add_u32 s18, s18, 0x1310000
  s_mul_i32 s19, s16, 131072
  s_add_u32 s19, s19, 0x110000
  s_mov_b32 s20, 1024
  v_mul_lo_u32 v7, v5, s20
  v_lshl_add_u32 v7, v6, 4, v7
  v_add_u32 v8, s18, v7
  v_add_u32 v9, s18, v7
  v_add_u32 v9, 0x8000, v9
  v_add_u32 v10, s18, v7
  v_add_u32 v10, 0x10000, v10
  v_add_u32 v11, s18, v7
  v_add_u32 v11, 0x18000, v11
  v_add_u32 v12, s19, v7
  v_add_u32 v13, s19, v7
  v_add_u32 v13, 0x8000, v13
  v_add_u32 v14, s19, v7
  v_add_u32 v14, 0x10000, v14
  v_add_u32 v15, s19, v7
  v_add_u32 v15, 0x18000, v15
  s_movk_i32 s21, 144
  v_mul_lo_u32 v16, v5, s21
  v_lshl_add_u32 v16, v6, 4, v16
  v_lshrrev_b32 v7, 1, v2
  v_mul_u32_u24 v7, 64, v7
  v_add_u32 v7, v7, v3
  v_mul_lo_u32 v17, v7, s21
  v_lshl_add_u32 v17, v4, 4, v17
  v_and_b32 v7, 1, v2
  v_mul_u32_u24 v7, 64, v7
  v_add_u32 v7, v7, v3
  v_mul_lo_u32 v18, v7, s21
  v_lshl_add_u32 v18, v4, 4, v18
  v_add_u32 v18, 18432, v18
  v_add_u32 v19, 36864, v16
  v_add_u32 v20, 36864, v17
  v_add_u32 v21, 36864, v18
  v_mov_b32 v120, 0
  v_mov_b32 v121, 0
  v_mov_b32 v122, 0
  v_mov_b32 v123, 0
  v_mov_b32 v124, 0
  v_mov_b32 v125, 0
  v_mov_b32 v126, 0
  v_mov_b32 v127, 0
  v_mov_b32 v128, 0
  v_mov_b32 v129, 0
  v_mov_b32 v130, 0
  v_mov_b32 v131, 0
  v_mov_b32 v132, 0
  v_mov_b32 v133, 0
  v_mov_b32 v134, 0
  v_mov_b32 v135, 0
  v_mov_b32 v136, 0
  v_mov_b32 v137, 0
  v_mov_b32 v138, 0
  v_mov_b32 v139, 0
  v_mov_b32 v140, 0
  v_mov_b32 v141, 0
  v_mov_b32 v142, 0
  v_mov_b32 v143, 0
  v_mov_b32 v144, 0
  v_mov_b32 v145, 0
  v_mov_b32 v146, 0
  v_mov_b32 v147, 0
  v_mov_b32 v148, 0
  v_mov_b32 v149, 0
  v_mov_b32 v150, 0
  v_mov_b32 v151, 0
  v_mov_b32 v152, 0
  v_mov_b32 v153, 0
  v_mov_b32 v154, 0
  v_mov_b32 v155, 0
  v_mov_b32 v156, 0
  v_mov_b32 v157, 0
  v_mov_b32 v158, 0
  v_mov_b32 v159, 0
  v_mov_b32 v160, 0
  v_mov_b32 v161, 0
  v_mov_b32 v162, 0
  v_mov_b32 v163, 0
  v_mov_b32 v164, 0
  v_mov_b32 v165, 0
  v_mov_b32 v166, 0
  v_mov_b32 v167, 0
  v_mov_b32 v168, 0
  v_mov_b32 v169, 0
  v_mov_b32 v170, 0
  v_mov_b32 v171, 0
  v_mov_b32 v172, 0
  v_mov_b32 v173, 0
  v_mov_b32 v174, 0
  v_mov_b32 v175, 0
  v_mov_b32 v176, 0
  v_mov_b32 v177, 0
  v_mov_b32 v178, 0
  v_mov_b32 v179, 0
  v_mov_b32 v180, 0
  v_mov_b32 v181, 0
  v_mov_b32 v182, 0
  v_mov_b32 v183, 0
  s_cmp_ge_u32 s16, 64
  s_cbranch_scc1 .Lg3_kernel_swapped2
  s_mov_b32 s18, 0
  buffer_load_dwordx4 v[24:27], v8, s[4:7], s18 offen
  buffer_load_dwordx4 v[28:31], v9, s[4:7], s18 offen
  buffer_load_dwordx4 v[32:35], v10, s[4:7], s18 offen
  buffer_load_dwordx4 v[36:39], v11, s[4:7], s18 offen
  buffer_load_dwordx4 v[40:43], v12, s[4:7], s18 offen
  buffer_load_dwordx4 v[44:47], v13, s[4:7], s18 offen
  buffer_load_dwordx4 v[48:51], v14, s[4:7], s18 offen
  buffer_load_dwordx4 v[52:55], v15, s[4:7], s18 offen
  s_movk_i32 s18, 128
  buffer_load_dwordx4 v[56:59], v8, s[4:7], s18 offen
  buffer_load_dwordx4 v[60:63], v9, s[4:7], s18 offen
  buffer_load_dwordx4 v[64:67], v10, s[4:7], s18 offen
  buffer_load_dwordx4 v[68:71], v11, s[4:7], s18 offen
  buffer_load_dwordx4 v[72:75], v12, s[4:7], s18 offen
  buffer_load_dwordx4 v[76:79], v13, s[4:7], s18 offen
  buffer_load_dwordx4 v[80:83], v14, s[4:7], s18 offen
  buffer_load_dwordx4 v[84:87], v15, s[4:7], s18 offen
  s_waitcnt vmcnt(8)
  ds_write_b128 v16, v[24:27] offset:0
  ds_write_b128 v16, v[28:31] offset:4608
  ds_write_b128 v16, v[32:35] offset:9216
  ds_write_b128 v16, v[36:39] offset:13824
  ds_write_b128 v16, v[40:43] offset:18432
  ds_write_b128 v16, v[44:47] offset:23040
  ds_write_b128 v16, v[48:51] offset:27648
  ds_write_b128 v16, v[52:55] offset:32256
  s_waitcnt lgkmcnt(0)
  s_barrier
  s_mov_b32 s22, 0
  .Lg3_kernel_loop4:
  s_add_u32 s18, s18, 128
  s_cmp_lt_u32 s22, 6
  s_cbranch_scc0 .Lg3_kernel_skl5
  buffer_load_dwordx4 v[24:27], v8, s[4:7], s18 offen
  buffer_load_dwordx4 v[28:31], v9, s[4:7], s18 offen
  buffer_load_dwordx4 v[32:35], v10, s[4:7], s18 offen
  buffer_load_dwordx4 v[36:39], v11, s[4:7], s18 offen
  buffer_load_dwordx4 v[40:43], v12, s[4:7], s18 offen
  buffer_load_dwordx4 v[44:47], v13, s[4:7], s18 offen
  buffer_load_dwordx4 v[48:51], v14, s[4:7], s18 offen
  buffer_load_dwordx4 v[52:55], v15, s[4:7], s18 offen
  .Lg3_kernel_skl5:
  ds_read_b128 v[88:91], v17 offset:0
  ds_read_b128 v[92:95], v17 offset:4608
  ds_read_b128 v[96:99], v18 offset:0
  ds_read_b128 v[100:103], v18 offset:4608
  ds_read_b128 v[104:107], v17 offset:32
  ds_read_b128 v[108:111], v17 offset:4640
  ds_read_b128 v[112:115], v18 offset:32
  ds_read_b128 v[116:119], v18 offset:4640
  s_waitcnt lgkmcnt(4)
  v_mfma_f32_32x32x16_bf16 v[120:135], v[96:99], v[88:91], v[120:135]
  v_mfma_f32_32x32x16_bf16 v[136:151], v[96:99], v[92:95], v[136:151]
  v_mfma_f32_32x32x16_bf16 v[152:167], v[100:103], v[88:91], v[152:167]
  v_mfma_f32_32x32x16_bf16 v[168:183], v[100:103], v[92:95], v[168:183]
  ds_read_b128 v[88:91], v17 offset:64
  ds_read_b128 v[92:95], v17 offset:4672
  ds_read_b128 v[96:99], v18 offset:64
  ds_read_b128 v[100:103], v18 offset:4672
  s_waitcnt lgkmcnt(4)
  v_mfma_f32_32x32x16_bf16 v[120:135], v[112:115], v[104:107], v[120:135]
  v_mfma_f32_32x32x16_bf16 v[136:151], v[112:115], v[108:111], v[136:151]
  v_mfma_f32_32x32x16_bf16 v[152:167], v[116:119], v[104:107], v[152:167]
  v_mfma_f32_32x32x16_bf16 v[168:183], v[116:119], v[108:111], v[168:183]
  ds_read_b128 v[104:107], v17 offset:96
  ds_read_b128 v[108:111], v17 offset:4704
  ds_read_b128 v[112:115], v18 offset:96
  ds_read_b128 v[116:119], v18 offset:4704
  s_waitcnt lgkmcnt(4)
  v_mfma_f32_32x32x16_bf16 v[120:135], v[96:99], v[88:91], v[120:135]
  v_mfma_f32_32x32x16_bf16 v[136:151], v[96:99], v[92:95], v[136:151]
  v_mfma_f32_32x32x16_bf16 v[152:167], v[100:103], v[88:91], v[152:167]
  v_mfma_f32_32x32x16_bf16 v[168:183], v[100:103], v[92:95], v[168:183]
  s_waitcnt lgkmcnt(0)
  v_mfma_f32_32x32x16_bf16 v[120:135], v[112:115], v[104:107], v[120:135]
  v_mfma_f32_32x32x16_bf16 v[136:151], v[112:115], v[108:111], v[136:151]
  v_mfma_f32_32x32x16_bf16 v[152:167], v[116:119], v[104:107], v[152:167]
  v_mfma_f32_32x32x16_bf16 v[168:183], v[116:119], v[108:111], v[168:183]
  s_cmp_lt_u32 s22, 7
  s_cbranch_scc0 .Lg3_kernel_sks6
  s_cmp_lt_u32 s22, 6
  s_cbranch_scc0 .Lg3_kernel_skw7
  s_waitcnt vmcnt(8)
  .Lg3_kernel_skw7:
  s_cmp_lt_u32 s22, 6
  s_cbranch_scc1 .Lg3_kernel_skv8
  s_waitcnt vmcnt(0)
  .Lg3_kernel_skv8:
  ds_write_b128 v19, v[56:59] offset:0
  ds_write_b128 v19, v[60:63] offset:4608
  ds_write_b128 v19, v[64:67] offset:9216
  ds_write_b128 v19, v[68:71] offset:13824
  ds_write_b128 v19, v[72:75] offset:18432
  ds_write_b128 v19, v[76:79] offset:23040
  ds_write_b128 v19, v[80:83] offset:27648
  ds_write_b128 v19, v[84:87] offset:32256
  .Lg3_kernel_sks6:
  s_waitcnt lgkmcnt(0)
  s_barrier
  s_add_u32 s18, s18, 128
  s_cmp_lt_u32 s22, 5
  s_cbranch_scc0 .Lg3_kernel_skl9
  buffer_load_dwordx4 v[56:59], v8, s[4:7], s18 offen
  buffer_load_dwordx4 v[60:63], v9, s[4:7], s18 offen
  buffer_load_dwordx4 v[64:67], v10, s[4:7], s18 offen
  buffer_load_dwordx4 v[68:71], v11, s[4:7], s18 offen
  buffer_load_dwordx4 v[72:75], v12, s[4:7], s18 offen
  buffer_load_dwordx4 v[76:79], v13, s[4:7], s18 offen
  buffer_load_dwordx4 v[80:83], v14, s[4:7], s18 offen
  buffer_load_dwordx4 v[84:87], v15, s[4:7], s18 offen
  .Lg3_kernel_skl9:
  ds_read_b128 v[88:91], v20 offset:0
  ds_read_b128 v[92:95], v20 offset:4608
  ds_read_b128 v[96:99], v21 offset:0
  ds_read_b128 v[100:103], v21 offset:4608
  ds_read_b128 v[104:107], v20 offset:32
  ds_read_b128 v[108:111], v20 offset:4640
  ds_read_b128 v[112:115], v21 offset:32
  ds_read_b128 v[116:119], v21 offset:4640
  s_waitcnt lgkmcnt(4)
  v_mfma_f32_32x32x16_bf16 v[120:135], v[96:99], v[88:91], v[120:135]
  v_mfma_f32_32x32x16_bf16 v[136:151], v[96:99], v[92:95], v[136:151]
  v_mfma_f32_32x32x16_bf16 v[152:167], v[100:103], v[88:91], v[152:167]
  v_mfma_f32_32x32x16_bf16 v[168:183], v[100:103], v[92:95], v[168:183]
  ds_read_b128 v[88:91], v20 offset:64
  ds_read_b128 v[92:95], v20 offset:4672
  ds_read_b128 v[96:99], v21 offset:64
  ds_read_b128 v[100:103], v21 offset:4672
  s_waitcnt lgkmcnt(4)
  v_mfma_f32_32x32x16_bf16 v[120:135], v[112:115], v[104:107], v[120:135]
  v_mfma_f32_32x32x16_bf16 v[136:151], v[112:115], v[108:111], v[136:151]
  v_mfma_f32_32x32x16_bf16 v[152:167], v[116:119], v[104:107], v[152:167]
  v_mfma_f32_32x32x16_bf16 v[168:183], v[116:119], v[108:111], v[168:183]
  ds_read_b128 v[104:107], v20 offset:96
  ds_read_b128 v[108:111], v20 offset:4704
  ds_read_b128 v[112:115], v21 offset:96
  ds_read_b128 v[116:119], v21 offset:4704
  s_waitcnt lgkmcnt(4)
  v_mfma_f32_32x32x16_bf16 v[120:135], v[96:99], v[88:91], v[120:135]
  v_mfma_f32_32x32x16_bf16 v[136:151], v[96:99], v[92:95], v[136:151]
  v_mfma_f32_32x32x16_bf16 v[152:167], v[100:103], v[88:91], v[152:167]
  v_mfma_f32_32x32x16_bf16 v[168:183], v[100:103], v[92:95], v[168:183]
  s_waitcnt lgkmcnt(0)
  v_mfma_f32_32x32x16_bf16 v[120:135], v[112:115], v[104:107], v[120:135]
  v_mfma_f32_32x32x16_bf16 v[136:151], v[112:115], v[108:111], v[136:151]
  v_mfma_f32_32x32x16_bf16 v[152:167], v[116:119], v[104:107], v[152:167]
  v_mfma_f32_32x32x16_bf16 v[168:183], v[116:119], v[108:111], v[168:183]
  s_cmp_lt_u32 s22, 6
  s_cbranch_scc0 .Lg3_kernel_sks10
  s_cmp_lt_u32 s22, 5
  s_cbranch_scc0 .Lg3_kernel_skw11
  s_waitcnt vmcnt(8)
  .Lg3_kernel_skw11:
  s_cmp_lt_u32 s22, 5
  s_cbranch_scc1 .Lg3_kernel_skv12
  s_waitcnt vmcnt(0)
  .Lg3_kernel_skv12:
  ds_write_b128 v16, v[24:27] offset:0
  ds_write_b128 v16, v[28:31] offset:4608
  ds_write_b128 v16, v[32:35] offset:9216
  ds_write_b128 v16, v[36:39] offset:13824
  ds_write_b128 v16, v[40:43] offset:18432
  ds_write_b128 v16, v[44:47] offset:23040
  ds_write_b128 v16, v[48:51] offset:27648
  ds_write_b128 v16, v[52:55] offset:32256
  .Lg3_kernel_sks10:
  s_waitcnt lgkmcnt(0)
  s_barrier
  s_add_u32 s22, s22, 2
  s_cmp_lt_u32 s22, 8
  s_cbranch_scc1 .Lg3_kernel_loop4
  s_nop 15
  v_lshrrev_b32 v184, 1, v2
  v_and_b32 v185, 1, v2
  s_and_b32 s24, s16, 31
  s_lshl_b32 s25, s17, 2
  v_lshlrev_b32 v186, 8, v3
  v_lshl_add_u32 v186, v185, 7, v186
  v_lshl_add_u32 v186, v4, 3, v186
  v_lshl_add_u32 v186, v184, 19, v186
  s_mov_b32 s26, 0x1930000
  s_mov_b32 s27, 0x2930000
  s_cmp_lt_u32 s16, 32
  s_cselect_b32 s26, s26, s27
  s_add_u32 s27, s25, 0
  s_lshl_b32 s27, s27, 5
  s_add_u32 s27, s27, s24
  s_lshl_b32 s27, s27, 13
  s_add_u32 s27, s27, s26
  s_add_u32 s28, s25, 1
  s_lshl_b32 s28, s28, 5
  s_add_u32 s28, s28, s24
  s_lshl_b32 s28, s28, 13
  s_add_u32 s28, s28, s26
  v_cvt_pk_bf16_f32 v188, v120, v121
  v_cvt_pk_bf16_f32 v189, v122, v123
  buffer_store_dwordx2 v[188:189], v186, s[4:7], s27 offen offset:0
  s_nop 0
  v_cvt_pk_bf16_f32 v188, v124, v125
  v_cvt_pk_bf16_f32 v189, v126, v127
  buffer_store_dwordx2 v[188:189], v186, s[4:7], s27 offen offset:16
  s_nop 0
  v_cvt_pk_bf16_f32 v188, v128, v129
  v_cvt_pk_bf16_f32 v189, v130, v131
  buffer_store_dwordx2 v[188:189], v186, s[4:7], s27 offen offset:32
  s_nop 0
  v_cvt_pk_bf16_f32 v188, v132, v133
  v_cvt_pk_bf16_f32 v189, v134, v135
  buffer_store_dwordx2 v[188:189], v186, s[4:7], s27 offen offset:48
  s_nop 0
  v_cvt_pk_bf16_f32 v188, v136, v137
  v_cvt_pk_bf16_f32 v189, v138, v139
  buffer_store_dwordx2 v[188:189], v186, s[4:7], s28 offen offset:0
  s_nop 0
  v_cvt_pk_bf16_f32 v188, v140, v141
  v_cvt_pk_bf16_f32 v189, v142, v143
  buffer_store_dwordx2 v[188:189], v186, s[4:7], s28 offen offset:16
  s_nop 0
  v_cvt_pk_bf16_f32 v188, v144, v145
  v_cvt_pk_bf16_f32 v189, v146, v147
  buffer_store_dwordx2 v[188:189], v186, s[4:7], s28 offen offset:32
  s_nop 0
  v_cvt_pk_bf16_f32 v188, v148, v149
  v_cvt_pk_bf16_f32 v189, v150, v151
  buffer_store_dwordx2 v[188:189], v186, s[4:7], s28 offen offset:48
  s_nop 0
  v_cvt_pk_bf16_f32 v188, v152, v153
  v_cvt_pk_bf16_f32 v189, v154, v155
  buffer_store_dwordx2 v[188:189], v186, s[4:7], s27 offen offset:64
  s_nop 0
  v_cvt_pk_bf16_f32 v188, v156, v157
  v_cvt_pk_bf16_f32 v189, v158, v159
  buffer_store_dwordx2 v[188:189], v186, s[4:7], s27 offen offset:80
  s_nop 0
  v_cvt_pk_bf16_f32 v188, v160, v161
  v_cvt_pk_bf16_f32 v189, v162, v163
  buffer_store_dwordx2 v[188:189], v186, s[4:7], s27 offen offset:96
  s_nop 0
  v_cvt_pk_bf16_f32 v188, v164, v165
  v_cvt_pk_bf16_f32 v189, v166, v167
  buffer_store_dwordx2 v[188:189], v186, s[4:7], s27 offen offset:112
  s_nop 0
  v_cvt_pk_bf16_f32 v188, v168, v169
  v_cvt_pk_bf16_f32 v189, v170, v171
  buffer_store_dwordx2 v[188:189], v186, s[4:7], s28 offen offset:64
  s_nop 0
  v_cvt_pk_bf16_f32 v188, v172, v173
  v_cvt_pk_bf16_f32 v189, v174, v175
  buffer_store_dwordx2 v[188:189], v186, s[4:7], s28 offen offset:80
  s_nop 0
  v_cvt_pk_bf16_f32 v188, v176, v177
  v_cvt_pk_bf16_f32 v189, v178, v179
  buffer_store_dwordx2 v[188:189], v186, s[4:7], s28 offen offset:96
  s_nop 0
  v_cvt_pk_bf16_f32 v188, v180, v181
  v_cvt_pk_bf16_f32 v189, v182, v183
  buffer_store_dwordx2 v[188:189], v186, s[4:7], s28 offen offset:112
  s_nop 0
  s_branch .Lg3_kernel_tdone3
  .Lg3_kernel_swapped2:
  s_mov_b32 s18, 0
  buffer_load_dwordx4 v[24:27], v8, s[4:7], s18 offen
  buffer_load_dwordx4 v[28:31], v9, s[4:7], s18 offen
  buffer_load_dwordx4 v[32:35], v10, s[4:7], s18 offen
  buffer_load_dwordx4 v[36:39], v11, s[4:7], s18 offen
  buffer_load_dwordx4 v[40:43], v12, s[4:7], s18 offen
  buffer_load_dwordx4 v[44:47], v13, s[4:7], s18 offen
  buffer_load_dwordx4 v[48:51], v14, s[4:7], s18 offen
  buffer_load_dwordx4 v[52:55], v15, s[4:7], s18 offen
  s_movk_i32 s18, 128
  buffer_load_dwordx4 v[56:59], v8, s[4:7], s18 offen
  buffer_load_dwordx4 v[60:63], v9, s[4:7], s18 offen
  buffer_load_dwordx4 v[64:67], v10, s[4:7], s18 offen
  buffer_load_dwordx4 v[68:71], v11, s[4:7], s18 offen
  buffer_load_dwordx4 v[72:75], v12, s[4:7], s18 offen
  buffer_load_dwordx4 v[76:79], v13, s[4:7], s18 offen
  buffer_load_dwordx4 v[80:83], v14, s[4:7], s18 offen
  buffer_load_dwordx4 v[84:87], v15, s[4:7], s18 offen
  s_waitcnt vmcnt(8)
  ds_write_b128 v16, v[24:27] offset:0
  ds_write_b128 v16, v[28:31] offset:4608
  ds_write_b128 v16, v[32:35] offset:9216
  ds_write_b128 v16, v[36:39] offset:13824
  ds_write_b128 v16, v[40:43] offset:18432
  ds_write_b128 v16, v[44:47] offset:23040
  ds_write_b128 v16, v[48:51] offset:27648
  ds_write_b128 v16, v[52:55] offset:32256
  s_waitcnt lgkmcnt(0)
  s_barrier
  s_mov_b32 s22, 0
  .Lg3_kernel_loop13:
  s_add_u32 s18, s18, 128
  s_cmp_lt_u32 s22, 6
  s_cbranch_scc0 .Lg3_kernel_skl14
  buffer_load_dwordx4 v[24:27], v8, s[4:7], s18 offen
  buffer_load_dwordx4 v[28:31], v9, s[4:7], s18 offen
  buffer_load_dwordx4 v[32:35], v10, s[4:7], s18 offen
  buffer_load_dwordx4 v[36:39], v11, s[4:7], s18 offen
  buffer_load_dwordx4 v[40:43], v12, s[4:7], s18 offen
  buffer_load_dwordx4 v[44:47], v13, s[4:7], s18 offen
  buffer_load_dwordx4 v[48:51], v14, s[4:7], s18 offen
  buffer_load_dwordx4 v[52:55], v15, s[4:7], s18 offen
  .Lg3_kernel_skl14:
  ds_read_b128 v[88:91], v17 offset:0
  ds_read_b128 v[92:95], v17 offset:4608
  ds_read_b128 v[96:99], v18 offset:0
  ds_read_b128 v[100:103], v18 offset:4608
  ds_read_b128 v[104:107], v17 offset:32
  ds_read_b128 v[108:111], v17 offset:4640
  ds_read_b128 v[112:115], v18 offset:32
  ds_read_b128 v[116:119], v18 offset:4640
  s_waitcnt lgkmcnt(4)
  v_mfma_f32_32x32x16_bf16 v[120:135], v[88:91], v[96:99], v[120:135]
  v_mfma_f32_32x32x16_bf16 v[136:151], v[92:95], v[96:99], v[136:151]
  v_mfma_f32_32x32x16_bf16 v[152:167], v[88:91], v[100:103], v[152:167]
  v_mfma_f32_32x32x16_bf16 v[168:183], v[92:95], v[100:103], v[168:183]
  ds_read_b128 v[88:91], v17 offset:64
  ds_read_b128 v[92:95], v17 offset:4672
  ds_read_b128 v[96:99], v18 offset:64
  ds_read_b128 v[100:103], v18 offset:4672
  s_waitcnt lgkmcnt(4)
  v_mfma_f32_32x32x16_bf16 v[120:135], v[104:107], v[112:115], v[120:135]
  v_mfma_f32_32x32x16_bf16 v[136:151], v[108:111], v[112:115], v[136:151]
  v_mfma_f32_32x32x16_bf16 v[152:167], v[104:107], v[116:119], v[152:167]
  v_mfma_f32_32x32x16_bf16 v[168:183], v[108:111], v[116:119], v[168:183]
  ds_read_b128 v[104:107], v17 offset:96
  ds_read_b128 v[108:111], v17 offset:4704
  ds_read_b128 v[112:115], v18 offset:96
  ds_read_b128 v[116:119], v18 offset:4704
  s_waitcnt lgkmcnt(4)
  v_mfma_f32_32x32x16_bf16 v[120:135], v[88:91], v[96:99], v[120:135]
  v_mfma_f32_32x32x16_bf16 v[136:151], v[92:95], v[96:99], v[136:151]
  v_mfma_f32_32x32x16_bf16 v[152:167], v[88:91], v[100:103], v[152:167]
  v_mfma_f32_32x32x16_bf16 v[168:183], v[92:95], v[100:103], v[168:183]
  s_waitcnt lgkmcnt(0)
  v_mfma_f32_32x32x16_bf16 v[120:135], v[104:107], v[112:115], v[120:135]
  v_mfma_f32_32x32x16_bf16 v[136:151], v[108:111], v[112:115], v[136:151]
  v_mfma_f32_32x32x16_bf16 v[152:167], v[104:107], v[116:119], v[152:167]
  v_mfma_f32_32x32x16_bf16 v[168:183], v[108:111], v[116:119], v[168:183]
  s_cmp_lt_u32 s22, 7
  s_cbranch_scc0 .Lg3_kernel_sks15
  s_cmp_lt_u32 s22, 6
  s_cbranch_scc0 .Lg3_kernel_skw16
  s_waitcnt vmcnt(8)
  .Lg3_kernel_skw16:
  s_cmp_lt_u32 s22, 6
  s_cbranch_scc1 .Lg3_kernel_skv17
  s_waitcnt vmcnt(0)
  .Lg3_kernel_skv17:
  ds_write_b128 v19, v[56:59] offset:0
  ds_write_b128 v19, v[60:63] offset:4608
  ds_write_b128 v19, v[64:67] offset:9216
  ds_write_b128 v19, v[68:71] offset:13824
  ds_write_b128 v19, v[72:75] offset:18432
  ds_write_b128 v19, v[76:79] offset:23040
  ds_write_b128 v19, v[80:83] offset:27648
  ds_write_b128 v19, v[84:87] offset:32256
  .Lg3_kernel_sks15:
  s_waitcnt lgkmcnt(0)
  s_barrier
  s_add_u32 s18, s18, 128
  s_cmp_lt_u32 s22, 5
  s_cbranch_scc0 .Lg3_kernel_skl18
  buffer_load_dwordx4 v[56:59], v8, s[4:7], s18 offen
  buffer_load_dwordx4 v[60:63], v9, s[4:7], s18 offen
  buffer_load_dwordx4 v[64:67], v10, s[4:7], s18 offen
  buffer_load_dwordx4 v[68:71], v11, s[4:7], s18 offen
  buffer_load_dwordx4 v[72:75], v12, s[4:7], s18 offen
  buffer_load_dwordx4 v[76:79], v13, s[4:7], s18 offen
  buffer_load_dwordx4 v[80:83], v14, s[4:7], s18 offen
  buffer_load_dwordx4 v[84:87], v15, s[4:7], s18 offen
  .Lg3_kernel_skl18:
  ds_read_b128 v[88:91], v20 offset:0
  ds_read_b128 v[92:95], v20 offset:4608
  ds_read_b128 v[96:99], v21 offset:0
  ds_read_b128 v[100:103], v21 offset:4608
  ds_read_b128 v[104:107], v20 offset:32
  ds_read_b128 v[108:111], v20 offset:4640
  ds_read_b128 v[112:115], v21 offset:32
  ds_read_b128 v[116:119], v21 offset:4640
  s_waitcnt lgkmcnt(4)
  v_mfma_f32_32x32x16_bf16 v[120:135], v[88:91], v[96:99], v[120:135]
  v_mfma_f32_32x32x16_bf16 v[136:151], v[92:95], v[96:99], v[136:151]
  v_mfma_f32_32x32x16_bf16 v[152:167], v[88:91], v[100:103], v[152:167]
  v_mfma_f32_32x32x16_bf16 v[168:183], v[92:95], v[100:103], v[168:183]
  ds_read_b128 v[88:91], v20 offset:64
  ds_read_b128 v[92:95], v20 offset:4672
  ds_read_b128 v[96:99], v21 offset:64
  ds_read_b128 v[100:103], v21 offset:4672
  s_waitcnt lgkmcnt(4)
  v_mfma_f32_32x32x16_bf16 v[120:135], v[104:107], v[112:115], v[120:135]
  v_mfma_f32_32x32x16_bf16 v[136:151], v[108:111], v[112:115], v[136:151]
  v_mfma_f32_32x32x16_bf16 v[152:167], v[104:107], v[116:119], v[152:167]
  v_mfma_f32_32x32x16_bf16 v[168:183], v[108:111], v[116:119], v[168:183]
  ds_read_b128 v[104:107], v20 offset:96
  ds_read_b128 v[108:111], v20 offset:4704
  ds_read_b128 v[112:115], v21 offset:96
  ds_read_b128 v[116:119], v21 offset:4704
  s_waitcnt lgkmcnt(4)
  v_mfma_f32_32x32x16_bf16 v[120:135], v[88:91], v[96:99], v[120:135]
  v_mfma_f32_32x32x16_bf16 v[136:151], v[92:95], v[96:99], v[136:151]
  v_mfma_f32_32x32x16_bf16 v[152:167], v[88:91], v[100:103], v[152:167]
  v_mfma_f32_32x32x16_bf16 v[168:183], v[92:95], v[100:103], v[168:183]
  s_waitcnt lgkmcnt(0)
  v_mfma_f32_32x32x16_bf16 v[120:135], v[104:107], v[112:115], v[120:135]
  v_mfma_f32_32x32x16_bf16 v[136:151], v[108:111], v[112:115], v[136:151]
  v_mfma_f32_32x32x16_bf16 v[152:167], v[104:107], v[116:119], v[152:167]
  v_mfma_f32_32x32x16_bf16 v[168:183], v[108:111], v[116:119], v[168:183]
  s_cmp_lt_u32 s22, 6
  s_cbranch_scc0 .Lg3_kernel_sks19
  s_cmp_lt_u32 s22, 5
  s_cbranch_scc0 .Lg3_kernel_skw20
  s_waitcnt vmcnt(8)
  .Lg3_kernel_skw20:
  s_cmp_lt_u32 s22, 5
  s_cbranch_scc1 .Lg3_kernel_skv21
  s_waitcnt vmcnt(0)
  .Lg3_kernel_skv21:
  ds_write_b128 v16, v[24:27] offset:0
  ds_write_b128 v16, v[28:31] offset:4608
  ds_write_b128 v16, v[32:35] offset:9216
  ds_write_b128 v16, v[36:39] offset:13824
  ds_write_b128 v16, v[40:43] offset:18432
  ds_write_b128 v16, v[44:47] offset:23040
  ds_write_b128 v16, v[48:51] offset:27648
  ds_write_b128 v16, v[52:55] offset:32256
  .Lg3_kernel_sks19:
  s_waitcnt lgkmcnt(0)
  s_barrier
  s_add_u32 s22, s22, 2
  s_cmp_lt_u32 s22, 8
  s_cbranch_scc1 .Lg3_kernel_loop13
  s_nop 15
  v_lshrrev_b32 v184, 1, v2
  v_and_b32 v185, 1, v2
  s_and_b32 s24, s16, 31
  s_lshl_b32 s25, s17, 2
  v_lshlrev_b32 v186, 6, v3
  v_lshl_add_u32 v186, v185, 12, v186
  v_lshl_add_u32 v186, v4, 3, v186
  v_lshl_add_u32 v186, v184, 19, v186
  s_mov_b32 s26, 0x3930000
  s_add_u32 s27, s25, 0
  s_lshl_b32 s27, s27, 5
  s_add_u32 s27, s27, s24
  s_lshl_b32 s27, s27, 13
  s_add_u32 s27, s27, s26
  s_add_u32 s28, s25, 1
  s_lshl_b32 s28, s28, 5
  s_add_u32 s28, s28, s24
  s_lshl_b32 s28, s28, 13
  s_add_u32 s28, s28, s26
  v_cvt_pk_bf16_f32 v188, v120, v121
  v_cvt_pk_bf16_f32 v189, v122, v123
  buffer_store_dwordx2 v[188:189], v186, s[4:7], s27 offen offset:0
  s_nop 0
  v_cvt_pk_bf16_f32 v188, v124, v125
  v_cvt_pk_bf16_f32 v189, v126, v127
  buffer_store_dwordx2 v[188:189], v186, s[4:7], s27 offen offset:16
  s_nop 0
  v_cvt_pk_bf16_f32 v188, v128, v129
  v_cvt_pk_bf16_f32 v189, v130, v131
  buffer_store_dwordx2 v[188:189], v186, s[4:7], s27 offen offset:32
  s_nop 0
  v_cvt_pk_bf16_f32 v188, v132, v133
  v_cvt_pk_bf16_f32 v189, v134, v135
  buffer_store_dwordx2 v[188:189], v186, s[4:7], s27 offen offset:48
  s_nop 0
  v_cvt_pk_bf16_f32 v188, v136, v137
  v_cvt_pk_bf16_f32 v189, v138, v139
  buffer_store_dwordx2 v[188:189], v186, s[4:7], s28 offen offset:0
  s_nop 0
  v_cvt_pk_bf16_f32 v188, v140, v141
  v_cvt_pk_bf16_f32 v189, v142, v143
  buffer_store_dwordx2 v[188:189], v186, s[4:7], s28 offen offset:16
  s_nop 0
  v_cvt_pk_bf16_f32 v188, v144, v145
  v_cvt_pk_bf16_f32 v189, v146, v147
  buffer_store_dwordx2 v[188:189], v186, s[4:7], s28 offen offset:32
  s_nop 0
  v_cvt_pk_bf16_f32 v188, v148, v149
  v_cvt_pk_bf16_f32 v189, v150, v151
  buffer_store_dwordx2 v[188:189], v186, s[4:7], s28 offen offset:48
  s_nop 0
  v_cvt_pk_bf16_f32 v188, v152, v153
  v_cvt_pk_bf16_f32 v189, v154, v155
  buffer_store_dwordx2 v[188:189], v186, s[4:7], s27 offen offset:2048
  s_nop 0
  v_cvt_pk_bf16_f32 v188, v156, v157
  v_cvt_pk_bf16_f32 v189, v158, v159
  buffer_store_dwordx2 v[188:189], v186, s[4:7], s27 offen offset:2064
  s_nop 0
  v_cvt_pk_bf16_f32 v188, v160, v161
  v_cvt_pk_bf16_f32 v189, v162, v163
  buffer_store_dwordx2 v[188:189], v186, s[4:7], s27 offen offset:2080
  s_nop 0
  v_cvt_pk_bf16_f32 v188, v164, v165
  v_cvt_pk_bf16_f32 v189, v166, v167
  buffer_store_dwordx2 v[188:189], v186, s[4:7], s27 offen offset:2096
  s_nop 0
  v_cvt_pk_bf16_f32 v188, v168, v169
  v_cvt_pk_bf16_f32 v189, v170, v171
  buffer_store_dwordx2 v[188:189], v186, s[4:7], s28 offen offset:2048
  s_nop 0
  v_cvt_pk_bf16_f32 v188, v172, v173
  v_cvt_pk_bf16_f32 v189, v174, v175
  buffer_store_dwordx2 v[188:189], v186, s[4:7], s28 offen offset:2064
  s_nop 0
  v_cvt_pk_bf16_f32 v188, v176, v177
  v_cvt_pk_bf16_f32 v189, v178, v179
  buffer_store_dwordx2 v[188:189], v186, s[4:7], s28 offen offset:2080
  s_nop 0
  v_cvt_pk_bf16_f32 v188, v180, v181
  v_cvt_pk_bf16_f32 v189, v182, v183
  buffer_store_dwordx2 v[188:189], v186, s[4:7], s28 offen offset:2096
  s_nop 0
  .Lg3_kernel_tdone3:
  .Lg3_kernel_end1:
  s_endpgm

.globl g4_kernel
.p2align 8
.type g4_kernel,@function
g4_kernel:
  s_cmp_ge_u32 s2, 256
  s_cbranch_scc1 .Lg4_kernel_end1
  s_load_dwordx2 s[4:5], s[0:1], 112
  s_load_dwordx2 s[12:13], s[0:1], 96
  s_lshr_b32 s16, s2, 5
  s_lshr_b32 s17, s2, 3
  s_and_b32 s17, s17, 3
  s_lshl_b32 s17, s17, 3
  s_and_b32 s24, s2, 7
  s_add_u32 s17, s17, s24
  s_waitcnt lgkmcnt(0)
  s_and_b32 s5, s5, 0xffff
  s_mov_b32 s6, 0x10000000
  s_mov_b32 s7, 0x00020000
  s_and_b32 s13, s13, 0xffff
  s_mov_b32 s14, 0x200000
  s_mov_b32 s15, 0x00020000
  v_and_b32 v1, 63, v0
  v_lshrrev_b32 v2, 6, v0
  v_and_b32 v3, 31, v0
  v_bfe_u32 v4, v0, 5, 1
  v_lshrrev_b32 v5, 3, v0
  v_and_b32 v6, 7, v0
  s_mul_i32 s18, s17, 524288
  s_add_u32 s18, s18, 0x4930000
  s_mul_i32 s19, s16, 524288
  s_add_u32 s19, s19, 0xd10000
  s_mov_b32 s20, 8192
  v_mul_lo_u32 v7, v5, s20
  v_lshl_add_u32 v7, v6, 4, v7
  v_add_u32 v8, s18, v7
  v_add_u32 v9, s18, v7
  v_add_u32 v9, 0x40000, v9
  v_add_u32 v10, s19, v7
  v_add_u32 v11, s19, v7
  v_add_u32 v11, 0x40000, v11
  s_movk_i32 s21, 144
  v_mul_lo_u32 v12, v5, s21
  v_lshl_add_u32 v12, v6, 4, v12
  v_lshrrev_b32 v7, 1, v2
  v_mul_u32_u24 v7, 32, v7
  v_add_u32 v7, v7, v3
  v_mul_lo_u32 v13, v7, s21
  v_lshl_add_u32 v13, v4, 4, v13
  v_and_b32 v7, 1, v2
  v_mul_u32_u24 v7, 32, v7
  v_add_u32 v7, v7, v3
  v_mul_lo_u32 v14, v7, s21
  v_lshl_add_u32 v14, v4, 4, v14
  v_add_u32 v14, 9216, v14
  v_add_u32 v15, 18432, v12
  v_add_u32 v16, 18432, v13
  v_add_u32 v17, 18432, v14
  v_mov_b32 v68, 0
  v_mov_b32 v69, 0
  v_mov_b32 v70, 0
  v_mov_b32 v71, 0
  v_mov_b32 v72, 0
  v_mov_b32 v73, 0
  v_mov_b32 v74, 0
  v_mov_b32 v75, 0
  v_mov_b32 v76, 0
  v_mov_b32 v77, 0
  v_mov_b32 v78, 0
  v_mov_b32 v79, 0
  v_mov_b32 v80, 0
  v_mov_b32 v81, 0
  v_mov_b32 v82, 0
  v_mov_b32 v83, 0
  s_mov_b32 s18, 0
  buffer_load_dwordx4 v[20:23], v8, s[4:7], s18 offen
  buffer_load_dwordx4 v[24:27], v9, s[4:7], s18 offen
  buffer_load_dwordx4 v[28:31], v10, s[4:7], s18 offen
  buffer_load_dwordx4 v[32:35], v11, s[4:7], s18 offen
  s_movk_i32 s18, 128
  buffer_load_dwordx4 v[36:39], v8, s[4:7], s18 offen
  buffer_load_dwordx4 v[40:43], v9, s[4:7], s18 offen
  buffer_load_dwordx4 v[44:47], v10, s[4:7], s18 offen
  buffer_load_dwordx4 v[48:51], v11, s[4:7], s18 offen
  s_waitcnt vmcnt(4)
  ds_write_b128 v12, v[20:23] offset:0
  ds_write_b128 v12, v[24:27] offset:4608
  ds_write_b128 v12, v[28:31] offset:9216
  ds_write_b128 v12, v[32:35] offset:13824
  s_waitcnt lgkmcnt(0)
  s_barrier
  s_mov_b32 s22, 0
  .Lg4_kernel_loop2:
  s_add_u32 s18, s18, 128
  s_cmp_lt_u32 s22, 62
  s_cbranch_scc0 .Lg4_kernel_skl3
  buffer_load_dwordx4 v[20:23], v8, s[4:7], s18 offen
  buffer_load_dwordx4 v[24:27], v9, s[4:7], s18 offen
  buffer_load_dwordx4 v[28:31], v10, s[4:7], s18 offen
  buffer_load_dwordx4 v[32:35], v11, s[4:7], s18 offen
  .Lg4_kernel_skl3:
  ds_read_b128 v[52:55], v13 offset:0
  ds_read_b128 v[56:59], v14 offset:0
  ds_read_b128 v[60:63], v13 offset:32
  ds_read_b128 v[64:67], v14 offset:32
  s_waitcnt lgkmcnt(2)
  v_mfma_f32_32x32x16_bf16 v[68:83], v[56:59], v[52:55], v[68:83]
  ds_read_b128 v[52:55], v13 offset:64
  ds_read_b128 v[56:59], v14 offset:64
  s_waitcnt lgkmcnt(2)
  v_mfma_f32_32x32x16_bf16 v[68:83], v[64:67], v[60:63], v[68:83]
  ds_read_b128 v[60:63], v13 offset:96
  ds_read_b128 v[64:67], v14 offset:96
  s_waitcnt lgkmcnt(2)
  v_mfma_f32_32x32x16_bf16 v[68:83], v[56:59], v[52:55], v[68:83]
  s_waitcnt lgkmcnt(0)
  v_mfma_f32_32x32x16_bf16 v[68:83], v[64:67], v[60:63], v[68:83]
  s_cmp_lt_u32 s22, 63
  s_cbranch_scc0 .Lg4_kernel_sks4
  s_cmp_lt_u32 s22, 62
  s_cbranch_scc0 .Lg4_kernel_skw5
  s_waitcnt vmcnt(4)
  .Lg4_kernel_skw5:
  s_cmp_lt_u32 s22, 62
  s_cbranch_scc1 .Lg4_kernel_skv6
  s_waitcnt vmcnt(0)
  .Lg4_kernel_skv6:
  ds_write_b128 v15, v[36:39] offset:0
  ds_write_b128 v15, v[40:43] offset:4608
  ds_write_b128 v15, v[44:47] offset:9216
  ds_write_b128 v15, v[48:51] offset:13824
  .Lg4_kernel_sks4:
  s_waitcnt lgkmcnt(0)
  s_barrier
  s_add_u32 s18, s18, 128
  s_cmp_lt_u32 s22, 61
  s_cbranch_scc0 .Lg4_kernel_skl7
  buffer_load_dwordx4 v[36:39], v8, s[4:7], s18 offen
  buffer_load_dwordx4 v[40:43], v9, s[4:7], s18 offen
  buffer_load_dwordx4 v[44:47], v10, s[4:7], s18 offen
  buffer_load_dwordx4 v[48:51], v11, s[4:7], s18 offen
  .Lg4_kernel_skl7:
  ds_read_b128 v[52:55], v16 offset:0
  ds_read_b128 v[56:59], v17 offset:0
  ds_read_b128 v[60:63], v16 offset:32
  ds_read_b128 v[64:67], v17 offset:32
  s_waitcnt lgkmcnt(2)
  v_mfma_f32_32x32x16_bf16 v[68:83], v[56:59], v[52:55], v[68:83]
  ds_read_b128 v[52:55], v16 offset:64
  ds_read_b128 v[56:59], v17 offset:64
  s_waitcnt lgkmcnt(2)
  v_mfma_f32_32x32x16_bf16 v[68:83], v[64:67], v[60:63], v[68:83]
  ds_read_b128 v[60:63], v16 offset:96
  ds_read_b128 v[64:67], v17 offset:96
  s_waitcnt lgkmcnt(2)
  v_mfma_f32_32x32x16_bf16 v[68:83], v[56:59], v[52:55], v[68:83]
  s_waitcnt lgkmcnt(0)
  v_mfma_f32_32x32x16_bf16 v[68:83], v[64:67], v[60:63], v[68:83]
  s_cmp_lt_u32 s22, 62
  s_cbranch_scc0 .Lg4_kernel_sks8
  s_cmp_lt_u32 s22, 61
  s_cbranch_scc0 .Lg4_kernel_skw9
  s_waitcnt vmcnt(4)
  .Lg4_kernel_skw9:
  s_cmp_lt_u32 s22, 61
  s_cbranch_scc1 .Lg4_kernel_skv10
  s_waitcnt vmcnt(0)
  .Lg4_kernel_skv10:
  ds_write_b128 v12, v[20:23] offset:0
  ds_write_b128 v12, v[24:27] offset:4608
  ds_write_b128 v12, v[28:31] offset:9216
  ds_write_b128 v12, v[32:35] offset:13824
  .Lg4_kernel_sks8:
  s_waitcnt lgkmcnt(0)
  s_barrier
  s_add_u32 s22, s22, 2
  s_cmp_lt_u32 s22, 64
  s_cbranch_scc1 .Lg4_kernel_loop2
  s_nop 15
  v_lshrrev_b32 v84, 1, v2
  v_and_b32 v85, 1, v2
  s_mul_i32 s24, s17, 64
  v_mul_u32_u24 v86, 32, v84
  v_add3_u32 v86, v86, v3, s24
  v_lshlrev_b32 v86, 10, v86
  s_mul_i32 s25, s16, 128
  v_mul_u32_u24 v87, 64, v85
  v_add3_u32 v86, v86, v87, s25
  v_lshl_add_u32 v86, v4, 3, v86
  s_mov_b32 s26, 0x1110000
  s_add_u32 s27, s26, 0x8000
  s_movk_i32 s28, 0
  s_mov_b32 s29, 0x8000
  buffer_load_dwordx2 v[20:21], v86, s[4:7], s26 offen offset:0
  buffer_load_dwordx2 v[22:23], v86, s[4:7], s26 offen offset:16
  buffer_load_dwordx2 v[24:25], v86, s[4:7], s26 offen offset:32
  buffer_load_dwordx2 v[26:27], v86, s[4:7], s26 offen offset:48
  s_waitcnt vmcnt(3)
  v_cvt_pk_bf16_f32 v68, v68, v68
  v_lshlrev_b32 v68, 16, v68
  v_cvt_pk_bf16_f32 v69, v69, v69
  v_lshlrev_b32 v69, 16, v69
  v_cvt_pk_bf16_f32 v70, v70, v70
  v_lshlrev_b32 v70, 16, v70
  v_cvt_pk_bf16_f32 v71, v71, v71
  v_lshlrev_b32 v71, 16, v71
  v_lshlrev_b32 v88, 16, v20
  v_and_b32 v89, 0xffff0000, v20
  v_lshlrev_b32 v90, 16, v21
  v_and_b32 v91, 0xffff0000, v21
  v_add_f32 v88, v88, v68
  v_add_f32 v89, v89, v69
  v_add_f32 v90, v90, v70
  v_add_f32 v91, v91, v71
  v_cvt_pk_bf16_f32 v20, v88, v89
  v_cvt_pk_bf16_f32 v21, v90, v91
  s_waitcnt vmcnt(2)
  v_cvt_pk_bf16_f32 v72, v72, v72
  v_lshlrev_b32 v72, 16, v72
  v_cvt_pk_bf16_f32 v73, v73, v73
  v_lshlrev_b32 v73, 16, v73
  v_cvt_pk_bf16_f32 v74, v74, v74
  v_lshlrev_b32 v74, 16, v74
  v_cvt_pk_bf16_f32 v75, v75, v75
  v_lshlrev_b32 v75, 16, v75
  v_lshlrev_b32 v88, 16, v22
  v_and_b32 v89, 0xffff0000, v22
  v_lshlrev_b32 v90, 16, v23
  v_and_b32 v91, 0xffff0000, v23
  v_add_f32 v88, v88, v72
  v_add_f32 v89, v89, v73
  v_add_f32 v90, v90, v74
  v_add_f32 v91, v91, v75
  v_cvt_pk_bf16_f32 v22, v88, v89
  v_cvt_pk_bf16_f32 v23, v90, v91
  s_waitcnt vmcnt(1)
  v_cvt_pk_bf16_f32 v76, v76, v76
  v_lshlrev_b32 v76, 16, v76
  v_cvt_pk_bf16_f32 v77, v77, v77
  v_lshlrev_b32 v77, 16, v77
  v_cvt_pk_bf16_f32 v78, v78, v78
  v_lshlrev_b32 v78, 16, v78
  v_cvt_pk_bf16_f32 v79, v79, v79
  v_lshlrev_b32 v79, 16, v79
  v_lshlrev_b32 v88, 16, v24
  v_and_b32 v89, 0xffff0000, v24
  v_lshlrev_b32 v90, 16, v25
  v_and_b32 v91, 0xffff0000, v25
  v_add_f32 v88, v88, v76
  v_add_f32 v89, v89, v77
  v_add_f32 v90, v90, v78
  v_add_f32 v91, v91, v79
  v_cvt_pk_bf16_f32 v24, v88, v89
  v_cvt_pk_bf16_f32 v25, v90, v91
  s_waitcnt vmcnt(0)
  v_cvt_pk_bf16_f32 v80, v80, v80
  v_lshlrev_b32 v80, 16, v80
  v_cvt_pk_bf16_f32 v81, v81, v81
  v_lshlrev_b32 v81, 16, v81
  v_cvt_pk_bf16_f32 v82, v82, v82
  v_lshlrev_b32 v82, 16, v82
  v_cvt_pk_bf16_f32 v83, v83, v83
  v_lshlrev_b32 v83, 16, v83
  v_lshlrev_b32 v88, 16, v26
  v_and_b32 v89, 0xffff0000, v26
  v_lshlrev_b32 v90, 16, v27
  v_and_b32 v91, 0xffff0000, v27
  v_add_f32 v88, v88, v80
  v_add_f32 v89, v89, v81
  v_add_f32 v90, v90, v82
  v_add_f32 v91, v91, v83
  v_cvt_pk_bf16_f32 v26, v88, v89
  v_cvt_pk_bf16_f32 v27, v90, v91
  buffer_store_dwordx2 v[20:21], v86, s[4:7], s26 offen offset:0
  buffer_store_dwordx2 v[20:21], v86, s[12:15], s28 offen offset:0
  buffer_store_dwordx2 v[22:23], v86, s[4:7], s26 offen offset:16
  buffer_store_dwordx2 v[22:23], v86, s[12:15], s28 offen offset:16
  buffer_store_dwordx2 v[24:25], v86, s[4:7], s26 offen offset:32
  buffer_store_dwordx2 v[24:25], v86, s[12:15], s28 offen offset:32
  buffer_store_dwordx2 v[26:27], v86, s[4:7], s26 offen offset:48
  buffer_store_dwordx2 v[26:27], v86, s[12:15], s28 offen offset:48
  .Lg4_kernel_end1:
  s_endpgm

.globl attna_kernel
.p2align 8
.type attna_kernel,@function
attna_kernel:
  s_cmp_ge_u32 s2, 256
  s_cbranch_scc1 .Lattna_kernel_end1
  s_load_dwordx2 s[4:5], s[0:1], 112
  v_and_b32 v1, 63, v0
  v_lshrrev_b32 v2, 6, v0
  v_and_b32 v3, 31, v0
  v_bfe_u32 v4, v0, 5, 1
  s_lshr_b32 s16, s2, 3
  s_and_b32 s17, s2, 7
  s_waitcnt lgkmcnt(0)
  s_and_b32 s5, s5, 0xffff
  s_mov_b32 s6, 0x10000000
  s_mov_b32 s7, 0x00020000
  v_lshlrev_b32 v146, 4, v0
  s_mov_b32 s20, 0x1710000
  s_mov_b32 s21, 0x1720000
  v_lshrrev_b32 v147, 1, v0
  v_and_b32 v148, 1, v0
  v_and_b32 v149, 31, v147
  v_lshl_add_u32 v149, v148, 5, v149
  v_lshlrev_b32 v149, 4, v149
  v_lshrrev_b32 v147, 5, v147
  v_lshl_add_u32 v149, v147, 10, v149
  v_mov_b32 v150, v146
  buffer_load_dwordx4 v[44:47], v150, s[4:7], s20 offen
  v_add_u32 v150, 0x2000, v150
  buffer_load_dwordx4 v[48:51], v150, s[4:7], s20 offen
  v_add_u32 v150, 0x2000, v150
  buffer_load_dwordx4 v[52:55], v150, s[4:7], s20 offen
  v_add_u32 v150, 0x2000, v150
  buffer_load_dwordx4 v[56:59], v150, s[4:7], s20 offen
  v_add_u32 v150, 0x2000, v150
  buffer_load_dwordx4 v[60:63], v150, s[4:7], s20 offen
  v_add_u32 v150, 0x2000, v150
  buffer_load_dwordx4 v[64:67], v150, s[4:7], s20 offen
  v_add_u32 v150, 0x2000, v150
  buffer_load_dwordx4 v[68:71], v150, s[4:7], s20 offen
  v_add_u32 v150, 0x2000, v150
  buffer_load_dwordx4 v[72:75], v150, s[4:7], s20 offen
  v_add_u32 v150, 0x2000, v150
  v_mov_b32 v150, v146
  buffer_load_dwordx4 v[76:79], v150, s[4:7], s21 offen
  v_add_u32 v150, 0x2000, v150
  buffer_load_dwordx4 v[80:83], v150, s[4:7], s21 offen
  v_add_u32 v150, 0x2000, v150
  buffer_load_dwordx4 v[84:87], v150, s[4:7], s21 offen
  v_add_u32 v150, 0x2000, v150
  buffer_load_dwordx4 v[88:91], v150, s[4:7], s21 offen
  v_add_u32 v150, 0x2000, v150
  buffer_load_dwordx4 v[92:95], v150, s[4:7], s21 offen
  v_add_u32 v150, 0x2000, v150
  buffer_load_dwordx4 v[96:99], v150, s[4:7], s21 offen
  v_add_u32 v150, 0x2000, v150
  buffer_load_dwordx4 v[100:103], v150, s[4:7], s21 offen
  v_add_u32 v150, 0x2000, v150
  buffer_load_dwordx4 v[104:107], v150, s[4:7], s21 offen
  v_add_u32 v150, 0x2000, v150
  v_and_b32 v151, 255, v0
  v_lshrrev_b32 v151, 1, v151
  v_lshlrev_b32 v151, 9, v151
  v_lshrrev_b32 v152, 8, v0
  v_lshl_add_u32 v151, v152, 4, v151
  v_and_b32 v152, 1, v0
  v_lshl_add_u32 v151, v152, 3, v151
  v_add_u32 v151, 0x10000, v151
  v_mov_b32 v152, 0x3f803f80
  v_cmp_gt_u32 vcc, 256, v0
  v_cndmask_b32 v152, 0, v152, vcc
  v_mov_b32 v153, v152
  v_lshlrev_b32 v154, 3, v0
  v_add_u32 v154, 0x20000, v154
  ds_write_b64 v154, v[152:153]
  s_waitcnt vmcnt(15)
  ds_write_b128 v149, v[44:47] offset:0
  s_waitcnt vmcnt(14)
  ds_write_b128 v149, v[48:51] offset:8192
  s_waitcnt vmcnt(13)
  ds_write_b128 v149, v[52:55] offset:16384
  s_waitcnt vmcnt(12)
  ds_write_b128 v149, v[56:59] offset:24576
  s_waitcnt vmcnt(11)
  ds_write_b128 v149, v[60:63] offset:32768
  s_waitcnt vmcnt(10)
  ds_write_b128 v149, v[64:67] offset:40960
  s_waitcnt vmcnt(9)
  ds_write_b128 v149, v[68:71] offset:49152
  s_waitcnt vmcnt(8)
  ds_write_b128 v149, v[72:75] offset:57344
  s_waitcnt vmcnt(7)
  ds_write_b64 v151, v[76:77] offset:0
  ds_write_b64 v151, v[78:79] offset:256
  s_waitcnt vmcnt(6)
  ds_write_b64 v151, v[80:81] offset:32
  ds_write_b64 v151, v[82:83] offset:288
  s_waitcnt vmcnt(5)
  ds_write_b64 v151, v[84:85] offset:64
  ds_write_b64 v151, v[86:87] offset:320
  s_waitcnt vmcnt(4)
  ds_write_b64 v151, v[88:89] offset:96
  ds_write_b64 v151, v[90:91] offset:352
  s_waitcnt vmcnt(3)
  ds_write_b64 v151, v[92:93] offset:128
  ds_write_b64 v151, v[94:95] offset:384
  s_waitcnt vmcnt(2)
  ds_write_b64 v151, v[96:97] offset:160
  ds_write_b64 v151, v[98:99] offset:416
  s_waitcnt vmcnt(1)
  ds_write_b64 v151, v[100:101] offset:192
  ds_write_b64 v151, v[102:103] offset:448
  s_waitcnt vmcnt(0)
  ds_write_b64 v151, v[104:105] offset:224
  ds_write_b64 v151, v[106:107] offset:480
  s_lshl_b32 s18, s17, 8
  v_lshl_add_u32 v146, v2, 5, v3
  v_add_u32 v146, s18, v146
  v_lshlrev_b32 v146, 10, v146
  v_lshl_add_u32 v146, v4, 4, v146
  s_lshl_b32 s19, s16, 5
  s_add_u32 s19, s19, 0x1510000
  buffer_load_dwordx4 v[8:11], v146, s[4:7], s19 offen
  v_lshlrev_b32 v142, 4, v1
  v_lshlrev_b32 v143, 4, v3
  v_lshl_add_u32 v143, v4, 8, v143
  v_add_u32 v143, 0x10000, v143
  v_mov_b32 v147, 0x20800
  v_mov_b32 v148, 0x20000
  v_cmp_eq_u32 vcc, 16, v3
  v_cndmask_b32 v147, v147, v148, vcc
  v_cmp_gt_u32 vcc, 16, v3
  v_cndmask_b32 v143, v147, v143, vcc
  v_mov_b32 v148, 0x800
  v_cndmask_b32 v144, 0, v148, vcc
  v_mov_b32 v140, 0xff800000
  s_waitcnt vmcnt(0) lgkmcnt(0)
  s_barrier
  s_mov_b32 s22, 0
  .Lattna_kernel_p12:
  ds_read_b128 v[12:15], v142 offset:0
  ds_read_b128 v[16:19], v142 offset:1024
  ds_read_b128 v[20:23], v142 offset:2048
  ds_read_b128 v[24:27], v142 offset:3072
  s_waitcnt lgkmcnt(3)
  v_mfma_f32_32x32x16_bf16 v[44:59], v[12:15], v[8:11], 0
  s_waitcnt lgkmcnt(2)
  v_mfma_f32_32x32x16_bf16 v[60:75], v[16:19], v[8:11], 0
  s_waitcnt lgkmcnt(1)
  v_mfma_f32_32x32x16_bf16 v[76:91], v[20:23], v[8:11], 0
  s_waitcnt lgkmcnt(0)
  v_mfma_f32_32x32x16_bf16 v[92:107], v[24:27], v[8:11], 0
  v_add_u32 v142, 0x1000, v142
  s_nop 7
  v_max3_f32 v140, v140, v44, v45
  v_max3_f32 v140, v140, v46, v47
  v_max3_f32 v140, v140, v48, v49
  v_max3_f32 v140, v140, v50, v51
  v_max3_f32 v140, v140, v52, v53
  v_max3_f32 v140, v140, v54, v55
  v_max3_f32 v140, v140, v56, v57
  v_max3_f32 v140, v140, v58, v59
  v_max3_f32 v140, v140, v60, v61
  v_max3_f32 v140, v140, v62, v63
  v_max3_f32 v140, v140, v64, v65
  v_max3_f32 v140, v140, v66, v67
  v_max3_f32 v140, v140, v68, v69
  v_max3_f32 v140, v140, v70, v71
  v_max3_f32 v140, v140, v72, v73
  v_max3_f32 v140, v140, v74, v75
  v_max3_f32 v140, v140, v76, v77
  v_max3_f32 v140, v140, v78, v79
  v_max3_f32 v140, v140, v80, v81
  v_max3_f32 v140, v140, v82, v83
  v_max3_f32 v140, v140, v84, v85
  v_max3_f32 v140, v140, v86, v87
  v_max3_f32 v140, v140, v88, v89
  v_max3_f32 v140, v140, v90, v91
  v_max3_f32 v140, v140, v92, v93
  v_max3_f32 v140, v140, v94, v95
  v_max3_f32 v140, v140, v96, v97
  v_max3_f32 v140, v140, v98, v99
  v_max3_f32 v140, v140, v100, v101
  v_max3_f32 v140, v140, v102, v103
  v_max3_f32 v140, v140, v104, v105
  v_max3_f32 v140, v140, v106, v107
  s_add_u32 s22, s22, 1
  s_cmp_lt_u32 s22, 16
  s_cbranch_scc1 .Lattna_kernel_p12
  v_mov_b32 v146, v140
  s_nop 1
  v_permlane32_swap_b32 v140, v146
  v_max_f32 v140, v140, v146
  s_mov_b32 s30, 0x3eb8aa3b
  v_mul_f32 v141, s30, v140
  v_sub_f32 v141, 0, v141
  v_subrev_u32 v142, 0x10000, v142
  v_mov_b32 v124, 0
  v_mov_b32 v125, 0
  v_mov_b32 v126, 0
  v_mov_b32 v127, 0
  v_mov_b32 v128, 0
  v_mov_b32 v129, 0
  v_mov_b32 v130, 0
  v_mov_b32 v131, 0
  v_mov_b32 v132, 0
  v_mov_b32 v133, 0
  v_mov_b32 v134, 0
  v_mov_b32 v135, 0
  v_mov_b32 v136, 0
  v_mov_b32 v137, 0
  v_mov_b32 v138, 0
  v_mov_b32 v139, 0
  s_mov_b32 s22, 0
  .Lattna_kernel_p23:
  ds_read_b128 v[12:15], v142
  ds_read_b128 v[16:19], v142 offset:1024
  ds_read_b128 v[28:31], v143 offset:0
  ds_read_b128 v[32:35], v143 offset:512
  ds_read_b128 v[36:39], v143 offset:1024
  ds_read_b128 v[40:43], v143 offset:1536
  s_waitcnt lgkmcnt(5)
  v_mfma_f32_32x32x16_bf16 v[44:59], v[12:15], v[8:11], 0
  s_waitcnt lgkmcnt(4)
  v_mfma_f32_32x32x16_bf16 v[60:75], v[16:19], v[8:11], 0
  v_add_u32 v142, 0x800, v142
  v_add_u32 v143, v144, v143
  s_nop 8
  v_fma_f32 v44, v44, s30, v141
  v_fma_f32 v45, v45, s30, v141
  v_fma_f32 v46, v46, s30, v141
  v_fma_f32 v47, v47, s30, v141
  v_fma_f32 v48, v48, s30, v141
  v_fma_f32 v49, v49, s30, v141
  v_fma_f32 v50, v50, s30, v141
  v_fma_f32 v51, v51, s30, v141
  v_fma_f32 v52, v52, s30, v141
  v_fma_f32 v53, v53, s30, v141
  v_fma_f32 v54, v54, s30, v141
  v_fma_f32 v55, v55, s30, v141
  v_fma_f32 v56, v56, s30, v141
  v_fma_f32 v57, v57, s30, v141
  v_fma_f32 v58, v58, s30, v141
  v_fma_f32 v59, v59, s30, v141
  v_exp_f32 v44, v44
  v_exp_f32 v45, v45
  v_exp_f32 v46, v46
  v_exp_f32 v47, v47
  v_exp_f32 v48, v48
  v_exp_f32 v49, v49
  v_exp_f32 v50, v50
  v_exp_f32 v51, v51
  v_exp_f32 v52, v52
  v_exp_f32 v53, v53
  v_exp_f32 v54, v54
  v_exp_f32 v55, v55
  v_exp_f32 v56, v56
  v_exp_f32 v57, v57
  v_exp_f32 v58, v58
  v_exp_f32 v59, v59
  v_cvt_pk_bf16_f32 v108, v44, v45
  v_cvt_pk_bf16_f32 v109, v46, v47
  v_cvt_pk_bf16_f32 v110, v48, v49
  v_cvt_pk_bf16_f32 v111, v50, v51
  v_cvt_pk_bf16_f32 v112, v52, v53
  v_cvt_pk_bf16_f32 v113, v54, v55
  v_cvt_pk_bf16_f32 v114, v56, v57
  v_cvt_pk_bf16_f32 v115, v58, v59
  s_waitcnt lgkmcnt(2)
  s_nop 1
  v_mfma_f32_32x32x16_bf16 v[124:139], v[28:31], v[108:111], v[124:139]
  v_mfma_f32_32x32x16_bf16 v[124:139], v[32:35], v[112:115], v[124:139]
  v_fma_f32 v60, v60, s30, v141
  v_fma_f32 v61, v61, s30, v141
  v_fma_f32 v62, v62, s30, v141
  v_fma_f32 v63, v63, s30, v141
  v_fma_f32 v64, v64, s30, v141
  v_fma_f32 v65, v65, s30, v141
  v_fma_f32 v66, v66, s30, v141
  v_fma_f32 v67, v67, s30, v141
  v_fma_f32 v68, v68, s30, v141
  v_fma_f32 v69, v69, s30, v141
  v_fma_f32 v70, v70, s30, v141
  v_fma_f32 v71, v71, s30, v141
  v_fma_f32 v72, v72, s30, v141
  v_fma_f32 v73, v73, s30, v141
  v_fma_f32 v74, v74, s30, v141
  v_fma_f32 v75, v75, s30, v141
  v_exp_f32 v60, v60
  v_exp_f32 v61, v61
  v_exp_f32 v62, v62
  v_exp_f32 v63, v63
  v_exp_f32 v64, v64
  v_exp_f32 v65, v65
  v_exp_f32 v66, v66
  v_exp_f32 v67, v67
  v_exp_f32 v68, v68
  v_exp_f32 v69, v69
  v_exp_f32 v70, v70
  v_exp_f32 v71, v71
  v_exp_f32 v72, v72
  v_exp_f32 v73, v73
  v_exp_f32 v74, v74
  v_exp_f32 v75, v75
  v_cvt_pk_bf16_f32 v116, v60, v61
  v_cvt_pk_bf16_f32 v117, v62, v63
  v_cvt_pk_bf16_f32 v118, v64, v65
  v_cvt_pk_bf16_f32 v119, v66, v67
  v_cvt_pk_bf16_f32 v120, v68, v69
  v_cvt_pk_bf16_f32 v121, v70, v71
  v_cvt_pk_bf16_f32 v122, v72, v73
  v_cvt_pk_bf16_f32 v123, v74, v75
  s_waitcnt lgkmcnt(0)
  s_nop 1
  v_mfma_f32_32x32x16_bf16 v[124:139], v[36:39], v[116:119], v[124:139]
  v_mfma_f32_32x32x16_bf16 v[124:139], v[40:43], v[120:123], v[124:139]
  s_add_u32 s22, s22, 1
  s_cmp_lt_u32 s22, 32
  s_cbranch_scc1 .Lattna_kernel_p23
  s_nop 15
  v_mov_b32 v146, v132
  s_nop 1
  v_permlane32_swap_b32 v132, v146
  v_add_f32 v132, v132, v146
  v_rcp_f32 v147, v132
  s_nop 0
  v_fma_f32 v148, -v132, v147, 1.0
  v_fma_f32 v147, v148, v147, v147
  v_mul_f32 v124, v124, v147
  v_mul_f32 v125, v125, v147
  v_mul_f32 v126, v126, v147
  v_mul_f32 v127, v127, v147
  v_mul_f32 v128, v128, v147
  v_mul_f32 v129, v129, v147
  v_mul_f32 v130, v130, v147
  v_mul_f32 v131, v131, v147
  v_cvt_pk_bf16_f32 v150, v124, v125
  v_cvt_pk_bf16_f32 v151, v126, v127
  v_cvt_pk_bf16_f32 v152, v128, v129
  v_cvt_pk_bf16_f32 v153, v130, v131
  v_lshl_add_u32 v146, v2, 5, v3
  v_add_u32 v146, s18, v146
  v_lshlrev_b32 v146, 10, v146
  v_lshl_add_u32 v146, v4, 3, v146
  s_lshl_b32 s19, s16, 5
  s_add_u32 s19, s19, 0x1730000
  buffer_store_dwordx2 v[150:151], v146, s[4:7], s19 offen
  buffer_store_dwordx2 v[152:153], v146, s[4:7], s19 offen offset:16
  .Lattna_kernel_end1:
  s_endpgm

.globl chain_kernel
.p2align 8
.type chain_kernel,@function
chain_kernel:
  s_cmp_ge_u32 s2, 256
  s_cbranch_scc1 .Lchain_kernel_end1
  s_load_dwordx2 s[4:5], s[0:1], 112
  s_load_dwordx2 s[8:9], s[0:1], 48
  s_getreg_b32 s16, hwreg(HW_REG_XCC_ID)
  v_and_b32 v1, 63, v0
  v_lshrrev_b32 v124, 6, v0
  v_and_b32 v2, 15, v0
  v_bfe_u32 v3, v0, 4, 2
  s_nop 0
  v_readfirstlane_b32 s17, v124
  s_mov_b32 s26, 0x00ff00ff
  s_mov_b32 s27, 0x00ff00ff
  s_mov_b32 s28, -1
  s_mov_b32 s29, 0
  s_mov_b32 s32, 0x3db504f3
  s_mov_b32 s33, 0x3fb8aa3b
  s_waitcnt lgkmcnt(0)
  s_and_b32 s5, s5, 0xffff
  s_mov_b32 s6, 0x10000000
  s_mov_b32 s7, 0x00020000
  s_and_b32 s9, s9, 0xffff
  s_mov_b32 s10, 0x2000
  s_mov_b32 s11, 0x00020000
  s_and_b32 s16, s16, 7
  s_cmp_eq_u32 s17, 0
  s_cbranch_scc0 .Lchain_kernel_end1_tk
  s_lshl_b32 s34, s16, 7
  s_add_u32 s34, s34, 0x6230400
  v_mov_b32 v124, 1
  v_mov_b32 v125, 0
  s_mov_b64 exec, 1
  buffer_atomic_add v124, v125, s[4:7], s34 offen sc0
  s_waitcnt vmcnt(0)
  v_mov_b32 v125, 0x20000
  ds_write_b32 v125, v124
  s_mov_b64 exec, -1
  .Lchain_kernel_end1_tk:
  s_waitcnt lgkmcnt(0)
  s_barrier
  v_mov_b32 v125, 0x20000
  ds_read_b32 v124, v125
  s_waitcnt lgkmcnt(0)
  v_readfirstlane_b32 s35, v124
  s_barrier
  s_cmp_lg_u32 s16, 0
  s_cbranch_scc1 .Lchain_kernel_work2
  s_cmp_ge_u32 s35, 32
  s_cbranch_scc1 .Lchain_kernel_work2
  s_mov_b32 s16, s35
  v_lshlrev_b32 v4, 4, v1
  v_add_u32 v4, 0x20000, v4
  v_lshrrev_b32 v124, 1, v3
  v_lshlrev_b32 v5, 8, v124
  v_lshl_add_u32 v5, v2, 4, v5
  v_and_b32 v124, 1, v3
  v_lshl_add_u32 v5, v124, 3, v5
  s_lshl_b32 s34, s17, 10
  s_add_u32 s34, s34, 0x20000
  v_add_u32 v5, s34, v5
  v_lshlrev_b32 v6, 7, v3
  v_lshl_add_u32 v6, v2, 1, v6
  s_add_u32 s35, s34, 24576
  v_add_u32 v6, s35, v6
  v_lshlrev_b32 v7, 5, v2
  v_lshl_add_u32 v7, v3, 3, v7
  v_add_u32 v7, s35, v7
  v_lshlrev_b32 v8, 8, v2
  v_lshl_add_u32 v8, v3, 3, v8
  s_lshl_b32 s34, s17, 6
  v_add_u32 v8, s34, v8
  v_lshlrev_b32 v9, 6, v3
  v_lshl_add_u32 v9, v2, 1, v9
  s_lshl_b32 s34, s17, 9
  v_add_u32 v9, s34, v9
  v_lshlrev_b32 v10, 8, v2
  v_lshl_add_u32 v10, v3, 4, v10
  v_add_u32 v11, 0x1000, v10
  v_lshlrev_b32 v12, 6, v2
  v_lshl_add_u32 v12, v3, 3, v12
  s_lshl_b32 s34, s17, 11
  v_add_u32 v12, s34, v12
  v_and_b32 v124, 1, v3
  v_lshlrev_b32 v13, 8, v124
  v_lshrrev_b32 v124, 1, v3
  v_lshl_add_u32 v13, v124, 11, v13
  v_lshl_add_u32 v13, v2, 2, v13
  s_lshl_b32 s34, s17, 12
  v_add_u32 v13, s34, v13
  v_lshrrev_b32 v124, 5, v1
  v_lshlrev_b32 v14, 14, v124
  v_and_b32 v124, 31, v1
  v_lshl_add_u32 v14, v124, 4, v14
  v_lshlrev_b32 v15, 4, v0
  v_lshrrev_b32 v124, 5, v0
  v_lshlrev_b32 v16, 10, v124
  v_bfe_u32 v124, v0, 4, 1
  v_lshl_add_u32 v16, v124, 9, v16
  v_and_b32 v124, 1, v0
  v_lshl_add_u32 v16, v124, 8, v16
  v_bfe_u32 v124, v0, 1, 3
  v_lshl_add_u32 v16, v124, 4, v16
  v_add_u32 v16, 0x20000, v16
  v_lshlrev_b32 v17, 2, v1
  v_lshlrev_b32 v18, 4, v1
  s_lshl_b32 s34, s17, 15
  v_add_u32 v18, s34, v18
  v_mov_b32 v124, 0
  v_mov_b32 v125, 0
  v_mov_b32 v126, 0
  v_mov_b32 v127, 0
  v_lshlrev_b32 v92, 4, v0
  v_add_u32 v92, 0x20000, v92
  ds_write_b128 v92, v[124:127] offset:0
  ds_write_b128 v92, v[124:127] offset:4096
  ds_write_b128 v92, v[124:127] offset:8192
  ds_write_b128 v92, v[124:127] offset:12288
  ds_write_b128 v92, v[124:127] offset:16384
  ds_write_b128 v92, v[124:127] offset:20480
  ds_write_b128 v92, v[124:127] offset:24576
  v_lshlrev_b32 v93, 10, v2
  v_lshl_add_u32 v93, v3, 4, v93
  s_lshl_b32 s34, s17, 15
  v_add_u32 v93, s34, v93
  s_lshl_b32 s35, s16, 17
  s_add_u32 s35, s35, 0x110000
  s_add_u32 s36, s35, 0x0
  buffer_load_dwordx4 a[0:3], v93, s[4:7], s36 offen offset:0
  buffer_load_dwordx4 a[4:7], v93, s[4:7], s36 offen offset:64
  buffer_load_dwordx4 a[8:11], v93, s[4:7], s36 offen offset:128
  buffer_load_dwordx4 a[12:15], v93, s[4:7], s36 offen offset:192
  buffer_load_dwordx4 a[16:19], v93, s[4:7], s36 offen offset:256
  buffer_load_dwordx4 a[20:23], v93, s[4:7], s36 offen offset:320
  buffer_load_dwordx4 a[24:27], v93, s[4:7], s36 offen offset:384
  buffer_load_dwordx4 a[28:31], v93, s[4:7], s36 offen offset:448
  buffer_load_dwordx4 a[32:35], v93, s[4:7], s36 offen offset:512
  buffer_load_dwordx4 a[36:39], v93, s[4:7], s36 offen offset:576
  buffer_load_dwordx4 a[40:43], v93, s[4:7], s36 offen offset:640
  buffer_load_dwordx4 a[44:47], v93, s[4:7], s36 offen offset:704
  buffer_load_dwordx4 a[48:51], v93, s[4:7], s36 offen offset:768
  buffer_load_dwordx4 a[52:55], v93, s[4:7], s36 offen offset:832
  buffer_load_dwordx4 a[56:59], v93, s[4:7], s36 offen offset:896
  buffer_load_dwordx4 a[60:63], v93, s[4:7], s36 offen offset:960
  s_waitcnt vmcnt(0)
  s_add_u32 s36, s35, 0x4000
  buffer_load_dwordx4 a[64:67], v93, s[4:7], s36 offen offset:0
  buffer_load_dwordx4 a[68:71], v93, s[4:7], s36 offen offset:64
  buffer_load_dwordx4 a[72:75], v93, s[4:7], s36 offen offset:128
  buffer_load_dwordx4 a[76:79], v93, s[4:7], s36 offen offset:192
  buffer_load_dwordx4 a[80:83], v93, s[4:7], s36 offen offset:256
  buffer_load_dwordx4 a[84:87], v93, s[4:7], s36 offen offset:320
  buffer_load_dwordx4 a[88:91], v93, s[4:7], s36 offen offset:384
  buffer_load_dwordx4 a[92:95], v93, s[4:7], s36 offen offset:448
  buffer_load_dwordx4 a[96:99], v93, s[4:7], s36 offen offset:512
  buffer_load_dwordx4 a[100:103], v93, s[4:7], s36 offen offset:576
  buffer_load_dwordx4 a[104:107], v93, s[4:7], s36 offen offset:640
  buffer_load_dwordx4 a[108:111], v93, s[4:7], s36 offen offset:704
  buffer_load_dwordx4 a[112:115], v93, s[4:7], s36 offen offset:768
  buffer_load_dwordx4 a[116:119], v93, s[4:7], s36 offen offset:832
  buffer_load_dwordx4 a[120:123], v93, s[4:7], s36 offen offset:896
  buffer_load_dwordx4 a[124:127], v93, s[4:7], s36 offen offset:960
  s_waitcnt vmcnt(0)
  s_add_u32 s36, s35, 0x400000
  buffer_load_dwordx4 a[128:131], v93, s[4:7], s36 offen offset:0
  buffer_load_dwordx4 a[132:135], v93, s[4:7], s36 offen offset:64
  buffer_load_dwordx4 a[136:139], v93, s[4:7], s36 offen offset:128
  buffer_load_dwordx4 a[140:143], v93, s[4:7], s36 offen offset:192
  buffer_load_dwordx4 a[144:147], v93, s[4:7], s36 offen offset:256
  buffer_load_dwordx4 a[148:151], v93, s[4:7], s36 offen offset:320
  buffer_load_dwordx4 a[152:155], v93, s[4:7], s36 offen offset:384
  buffer_load_dwordx4 a[156:159], v93, s[4:7], s36 offen offset:448
  buffer_load_dwordx4 a[160:163], v93, s[4:7], s36 offen offset:512
  buffer_load_dwordx4 a[164:167], v93, s[4:7], s36 offen offset:576
  buffer_load_dwordx4 a[168:171], v93, s[4:7], s36 offen offset:640
  buffer_load_dwordx4 a[172:175], v93, s[4:7], s36 offen offset:704
  buffer_load_dwordx4 a[176:179], v93, s[4:7], s36 offen offset:768
  buffer_load_dwordx4 a[180:183], v93, s[4:7], s36 offen offset:832
  buffer_load_dwordx4 a[184:187], v93, s[4:7], s36 offen offset:896
  buffer_load_dwordx4 a[188:191], v93, s[4:7], s36 offen offset:960
  s_waitcnt vmcnt(0)
  s_add_u32 s36, s35, 0x404000
  buffer_load_dwordx4 a[192:195], v93, s[4:7], s36 offen offset:0
  buffer_load_dwordx4 a[196:199], v93, s[4:7], s36 offen offset:64
  buffer_load_dwordx4 a[200:203], v93, s[4:7], s36 offen offset:128
  buffer_load_dwordx4 a[204:207], v93, s[4:7], s36 offen offset:192
  buffer_load_dwordx4 a[208:211], v93, s[4:7], s36 offen offset:256
  buffer_load_dwordx4 a[212:215], v93, s[4:7], s36 offen offset:320
  buffer_load_dwordx4 a[216:219], v93, s[4:7], s36 offen offset:384
  buffer_load_dwordx4 a[220:223], v93, s[4:7], s36 offen offset:448
  buffer_load_dwordx4 a[224:227], v93, s[4:7], s36 offen offset:512
  buffer_load_dwordx4 a[228:231], v93, s[4:7], s36 offen offset:576
  buffer_load_dwordx4 a[232:235], v93, s[4:7], s36 offen offset:640
  buffer_load_dwordx4 a[236:239], v93, s[4:7], s36 offen offset:704
  buffer_load_dwordx4 a[240:243], v93, s[4:7], s36 offen offset:768
  buffer_load_dwordx4 a[244:247], v93, s[4:7], s36 offen offset:832
  buffer_load_dwordx4 a[248:251], v93, s[4:7], s36 offen offset:896
  buffer_load_dwordx4 a[252:255], v93, s[4:7], s36 offen offset:960
  s_waitcnt vmcnt(0)
  s_add_u32 s36, s35, 0x800000
  buffer_load_dwordx4 v[128:131], v93, s[4:7], s36 offen offset:0
  buffer_load_dwordx4 v[132:135], v93, s[4:7], s36 offen offset:64
  buffer_load_dwordx4 v[136:139], v93, s[4:7], s36 offen offset:128
  buffer_load_dwordx4 v[140:143], v93, s[4:7], s36 offen offset:192
  buffer_load_dwordx4 v[144:147], v93, s[4:7], s36 offen offset:256
  buffer_load_dwordx4 v[148:151], v93, s[4:7], s36 offen offset:320
  buffer_load_dwordx4 v[152:155], v93, s[4:7], s36 offen offset:384
  buffer_load_dwordx4 v[156:159], v93, s[4:7], s36 offen offset:448
  buffer_load_dwordx4 v[160:163], v93, s[4:7], s36 offen offset:512
  buffer_load_dwordx4 v[164:167], v93, s[4:7], s36 offen offset:576
  buffer_load_dwordx4 v[168:171], v93, s[4:7], s36 offen offset:640
  buffer_load_dwordx4 v[172:175], v93, s[4:7], s36 offen offset:704
  buffer_load_dwordx4 v[176:179], v93, s[4:7], s36 offen offset:768
  buffer_load_dwordx4 v[180:183], v93, s[4:7], s36 offen offset:832
  buffer_load_dwordx4 v[184:187], v93, s[4:7], s36 offen offset:896
  buffer_load_dwordx4 v[188:191], v93, s[4:7], s36 offen offset:960
  s_waitcnt vmcnt(0)
  s_add_u32 s36, s35, 0x804000
  buffer_load_dwordx4 v[192:195], v93, s[4:7], s36 offen offset:0
  buffer_load_dwordx4 v[196:199], v93, s[4:7], s36 offen offset:64
  buffer_load_dwordx4 v[200:203], v93, s[4:7], s36 offen offset:128
  buffer_load_dwordx4 v[204:207], v93, s[4:7], s36 offen offset:192
  buffer_load_dwordx4 v[208:211], v93, s[4:7], s36 offen offset:256
  buffer_load_dwordx4 v[212:215], v93, s[4:7], s36 offen offset:320
  buffer_load_dwordx4 v[216:219], v93, s[4:7], s36 offen offset:384
  buffer_load_dwordx4 v[220:223], v93, s[4:7], s36 offen offset:448
  buffer_load_dwordx4 v[224:227], v93, s[4:7], s36 offen offset:512
  buffer_load_dwordx4 v[228:231], v93, s[4:7], s36 offen offset:576
  buffer_load_dwordx4 v[232:235], v93, s[4:7], s36 offen offset:640
  buffer_load_dwordx4 v[236:239], v93, s[4:7], s36 offen offset:704
  buffer_load_dwordx4 v[240:243], v93, s[4:7], s36 offen offset:768
  buffer_load_dwordx4 v[244:247], v93, s[4:7], s36 offen offset:832
  buffer_load_dwordx4 v[248:251], v93, s[4:7], s36 offen offset:896
  buffer_load_dwordx4 v[252:255], v93, s[4:7], s36 offen offset:960
  s_waitcnt vmcnt(0)
  v_lshlrev_b32 v93, 13, v2
  v_lshl_add_u32 v93, v3, 4, v93
  s_lshl_b32 s34, s17, 20
  s_lshl_b32 s35, s16, 8
  s_add_u32 s34, s34, s35
  s_add_u32 s34, s34, 0xd10000
  s_add_u32 s36, s34, 0x0
  buffer_load_dwordx4 v[60:63], v93, s[4:7], s36 offen offset:0
  buffer_load_dwordx4 v[64:67], v93, s[4:7], s36 offen offset:64
  buffer_load_dwordx4 v[68:71], v93, s[4:7], s36 offen offset:128
  buffer_load_dwordx4 v[72:75], v93, s[4:7], s36 offen offset:192
  s_waitcnt vmcnt(0)
  ds_write_b128 v18, v[60:63] offset:0
  ds_write_b128 v18, v[64:67] offset:1024
  ds_write_b128 v18, v[68:71] offset:2048
  ds_write_b128 v18, v[72:75] offset:3072
  s_add_u32 s36, s34, 0x20000
  buffer_load_dwordx4 v[60:63], v93, s[4:7], s36 offen offset:0
  buffer_load_dwordx4 v[64:67], v93, s[4:7], s36 offen offset:64
  buffer_load_dwordx4 v[68:71], v93, s[4:7], s36 offen offset:128
  buffer_load_dwordx4 v[72:75], v93, s[4:7], s36 offen offset:192
  s_waitcnt vmcnt(0)
  ds_write_b128 v18, v[60:63] offset:4096
  ds_write_b128 v18, v[64:67] offset:5120
  ds_write_b128 v18, v[68:71] offset:6144
  ds_write_b128 v18, v[72:75] offset:7168
  s_add_u32 s36, s34, 0x40000
  buffer_load_dwordx4 v[60:63], v93, s[4:7], s36 offen offset:0
  buffer_load_dwordx4 v[64:67], v93, s[4:7], s36 offen offset:64
  buffer_load_dwordx4 v[68:71], v93, s[4:7], s36 offen offset:128
  buffer_load_dwordx4 v[72:75], v93, s[4:7], s36 offen offset:192
  s_waitcnt vmcnt(0)
  ds_write_b128 v18, v[60:63] offset:8192
  ds_write_b128 v18, v[64:67] offset:9216
  ds_write_b128 v18, v[68:71] offset:10240
  ds_write_b128 v18, v[72:75] offset:11264
  s_add_u32 s36, s34, 0x60000
  buffer_load_dwordx4 v[60:63], v93, s[4:7], s36 offen offset:0
  buffer_load_dwordx4 v[64:67], v93, s[4:7], s36 offen offset:64
  buffer_load_dwordx4 v[68:71], v93, s[4:7], s36 offen offset:128
  buffer_load_dwordx4 v[72:75], v93, s[4:7], s36 offen offset:192
  s_waitcnt vmcnt(0)
  ds_write_b128 v18, v[60:63] offset:12288
  ds_write_b128 v18, v[64:67] offset:13312
  ds_write_b128 v18, v[68:71] offset:14336
  ds_write_b128 v18, v[72:75] offset:15360
  s_add_u32 s36, s34, 0x80000
  buffer_load_dwordx4 v[60:63], v93, s[4:7], s36 offen offset:0
  buffer_load_dwordx4 v[64:67], v93, s[4:7], s36 offen offset:64
  buffer_load_dwordx4 v[68:71], v93, s[4:7], s36 offen offset:128
  buffer_load_dwordx4 v[72:75], v93, s[4:7], s36 offen offset:192
  s_waitcnt vmcnt(0)
  ds_write_b128 v18, v[60:63] offset:16384
  ds_write_b128 v18, v[64:67] offset:17408
  ds_write_b128 v18, v[68:71] offset:18432
  ds_write_b128 v18, v[72:75] offset:19456
  s_add_u32 s36, s34, 0xa0000
  buffer_load_dwordx4 v[60:63], v93, s[4:7], s36 offen offset:0
  buffer_load_dwordx4 v[64:67], v93, s[4:7], s36 offen offset:64
  buffer_load_dwordx4 v[68:71], v93, s[4:7], s36 offen offset:128
  buffer_load_dwordx4 v[72:75], v93, s[4:7], s36 offen offset:192
  s_waitcnt vmcnt(0)
  ds_write_b128 v18, v[60:63] offset:20480
  ds_write_b128 v18, v[64:67] offset:21504
  ds_write_b128 v18, v[68:71] offset:22528
  ds_write_b128 v18, v[72:75] offset:23552
  s_add_u32 s36, s34, 0xc0000
  buffer_load_dwordx4 v[60:63], v93, s[4:7], s36 offen offset:0
  buffer_load_dwordx4 v[64:67], v93, s[4:7], s36 offen offset:64
  buffer_load_dwordx4 v[68:71], v93, s[4:7], s36 offen offset:128
  buffer_load_dwordx4 v[72:75], v93, s[4:7], s36 offen offset:192
  s_waitcnt vmcnt(0)
  ds_write_b128 v18, v[60:63] offset:24576
  ds_write_b128 v18, v[64:67] offset:25600
  ds_write_b128 v18, v[68:71] offset:26624
  ds_write_b128 v18, v[72:75] offset:27648
  s_add_u32 s36, s34, 0xe0000
  buffer_load_dwordx4 v[60:63], v93, s[4:7], s36 offen offset:0
  buffer_load_dwordx4 v[64:67], v93, s[4:7], s36 offen offset:64
  buffer_load_dwordx4 v[68:71], v93, s[4:7], s36 offen offset:128
  buffer_load_dwordx4 v[72:75], v93, s[4:7], s36 offen offset:192
  s_waitcnt vmcnt(0)
  ds_write_b128 v18, v[60:63] offset:28672
  ds_write_b128 v18, v[64:67] offset:29696
  ds_write_b128 v18, v[68:71] offset:30720
  ds_write_b128 v18, v[72:75] offset:31744
  s_waitcnt lgkmcnt(0)
  s_barrier
  v_lshlrev_b32 v92, 4, v0
  buffer_load_dwordx4 v[60:63], v92, s[8:11], 0 offen
  v_add_u32 v92, 0x1000, v92
  buffer_load_dwordx4 v[64:67], v92, s[8:11], 0 offen
  v_bfe_u32 v93, v0, 2, 4
  v_lshlrev_b32 v93, 10, v93
  v_and_b32 v94, 3, v0
  v_lshl_add_u32 v93, v94, 8, v93
  v_lshrrev_b32 v94, 6, v0
  v_lshl_add_u32 v93, v94, 4, v93
  v_add_u32 v93, 0x20000, v93
  s_waitcnt vmcnt(1)
  ds_write_b128 v93, v[60:63]
  s_waitcnt vmcnt(0)
  ds_write_b128 v93, v[64:67] offset:64
  v_mov_b32 v110, 0
  v_mov_b32 v111, 0
  v_mov_b32 v114, 0
  v_mov_b32 v115, 0
  v_mov_b32 v106, 0
  v_mov_b32 v107, 0
  s_mov_b32 s18, 0
  s_lshl_b32 s34, s18, 5
  s_add_u32 s34, s34, s16
  s_lshl_b32 s35, s34, 13
  s_add_u32 s19, s35, 0x2930000
  s_add_u32 s20, s35, 0x3930000
  s_lshl_b32 s35, s34, 11
  s_add_u32 s21, s35, 0x5930000
  s_add_u32 s22, s35, 0x5d30000
  s_and_b32 s35, s18, 1
  s_lshl_b32 s23, s35, 19
  s_add_u32 s23, s23, 0x6130000
  s_mov_b32 s24, s23
  s_lshl_b32 s36, s16, 9
  s_add_u32 s24, s24, s36
  s_lshl_b32 s36, s16, 14
  s_add_u32 s23, s23, s36
  s_lshl_b32 s39, s35, 13
  s_add_u32 s39, s39, 0x6232000
  buffer_load_dwordx4 v[20:23], v10, s[4:7], s19 offen offset:0
  buffer_load_dwordx4 v[24:27], v10, s[4:7], s19 offen offset:64
  buffer_load_dwordx4 v[28:31], v10, s[4:7], s19 offen offset:128
  buffer_load_dwordx4 v[32:35], v10, s[4:7], s19 offen offset:192
  buffer_load_dwordx4 v[36:39], v11, s[4:7], s19 offen offset:0
  buffer_load_dwordx4 v[40:43], v11, s[4:7], s19 offen offset:64
  buffer_load_dwordx4 v[44:47], v11, s[4:7], s19 offen offset:128
  buffer_load_dwordx4 v[48:51], v11, s[4:7], s19 offen offset:192
  buffer_load_dwordx2 v[52:53], v12, s[4:7], s20 offen offset:0
  buffer_load_dwordx2 v[54:55], v12, s[4:7], s20 offen offset:32
  buffer_load_dwordx2 v[56:57], v12, s[4:7], s20 offen offset:1024
  buffer_load_dwordx2 v[58:59], v12, s[4:7], s20 offen offset:1056
  s_waitcnt lgkmcnt(0)
  s_barrier
  .Lchain_kernel_step3:
  v_mov_b32 v60, 0
  v_mov_b32 v61, 0
  v_mov_b32 v62, 0
  v_mov_b32 v63, 0
  v_mov_b32 v64, 0
  v_mov_b32 v65, 0
  v_mov_b32 v66, 0
  v_mov_b32 v67, 0
  v_mov_b32 v68, 0
  v_mov_b32 v69, 0
  v_mov_b32 v70, 0
  v_mov_b32 v71, 0
  v_mov_b32 v72, 0
  v_mov_b32 v73, 0
  v_mov_b32 v74, 0
  v_mov_b32 v75, 0
  v_mov_b32 v76, 0
  v_mov_b32 v77, 0
  v_mov_b32 v78, 0
  v_mov_b32 v79, 0
  v_mov_b32 v80, 0
  v_mov_b32 v81, 0
  v_mov_b32 v82, 0
  v_mov_b32 v83, 0
  ds_read_b128 v[84:87], v4 offset:0
  ds_read_b128 v[88:91], v4 offset:1024
  s_waitcnt lgkmcnt(1)
  v_mfma_f32_16x16x32_bf16 v[60:63], a[0:3], v[84:87], v[60:63]
  v_mfma_f32_16x16x32_bf16 v[64:67], a[64:67], v[84:87], v[64:67]
  v_mfma_f32_16x16x32_bf16 v[68:71], a[128:131], v[84:87], v[68:71]
  v_mfma_f32_16x16x32_bf16 v[72:75], a[192:195], v[84:87], v[72:75]
  v_mfma_f32_16x16x32_bf16 v[76:79], v[128:131], v[84:87], v[76:79]
  v_mfma_f32_16x16x32_bf16 v[80:83], v[192:195], v[84:87], v[80:83]
  ds_read_b128 v[84:87], v4 offset:2048
  s_waitcnt lgkmcnt(1)
  v_mfma_f32_16x16x32_bf16 v[60:63], a[4:7], v[88:91], v[60:63]
  v_mfma_f32_16x16x32_bf16 v[64:67], a[68:71], v[88:91], v[64:67]
  v_mfma_f32_16x16x32_bf16 v[68:71], a[132:135], v[88:91], v[68:71]
  v_mfma_f32_16x16x32_bf16 v[72:75], a[196:199], v[88:91], v[72:75]
  v_mfma_f32_16x16x32_bf16 v[76:79], v[132:135], v[88:91], v[76:79]
  v_mfma_f32_16x16x32_bf16 v[80:83], v[196:199], v[88:91], v[80:83]
  ds_read_b128 v[88:91], v4 offset:3072
  s_waitcnt lgkmcnt(1)
  v_mfma_f32_16x16x32_bf16 v[60:63], a[8:11], v[84:87], v[60:63]
  v_mfma_f32_16x16x32_bf16 v[64:67], a[72:75], v[84:87], v[64:67]
  v_mfma_f32_16x16x32_bf16 v[68:71], a[136:139], v[84:87], v[68:71]
  v_mfma_f32_16x16x32_bf16 v[72:75], a[200:203], v[84:87], v[72:75]
  v_mfma_f32_16x16x32_bf16 v[76:79], v[136:139], v[84:87], v[76:79]
  v_mfma_f32_16x16x32_bf16 v[80:83], v[200:203], v[84:87], v[80:83]
  ds_read_b128 v[84:87], v4 offset:4096
  s_waitcnt lgkmcnt(1)
  v_mfma_f32_16x16x32_bf16 v[60:63], a[12:15], v[88:91], v[60:63]
  v_mfma_f32_16x16x32_bf16 v[64:67], a[76:79], v[88:91], v[64:67]
  v_mfma_f32_16x16x32_bf16 v[68:71], a[140:143], v[88:91], v[68:71]
  v_mfma_f32_16x16x32_bf16 v[72:75], a[204:207], v[88:91], v[72:75]
  v_mfma_f32_16x16x32_bf16 v[76:79], v[140:143], v[88:91], v[76:79]
  v_mfma_f32_16x16x32_bf16 v[80:83], v[204:207], v[88:91], v[80:83]
  ds_read_b128 v[88:91], v4 offset:5120
  s_waitcnt lgkmcnt(1)
  v_mfma_f32_16x16x32_bf16 v[60:63], a[16:19], v[84:87], v[60:63]
  v_mfma_f32_16x16x32_bf16 v[64:67], a[80:83], v[84:87], v[64:67]
  v_mfma_f32_16x16x32_bf16 v[68:71], a[144:147], v[84:87], v[68:71]
  v_mfma_f32_16x16x32_bf16 v[72:75], a[208:211], v[84:87], v[72:75]
  v_mfma_f32_16x16x32_bf16 v[76:79], v[144:147], v[84:87], v[76:79]
  v_mfma_f32_16x16x32_bf16 v[80:83], v[208:211], v[84:87], v[80:83]
  ds_read_b128 v[84:87], v4 offset:6144
  s_waitcnt lgkmcnt(1)
  v_mfma_f32_16x16x32_bf16 v[60:63], a[20:23], v[88:91], v[60:63]
  v_mfma_f32_16x16x32_bf16 v[64:67], a[84:87], v[88:91], v[64:67]
  v_mfma_f32_16x16x32_bf16 v[68:71], a[148:151], v[88:91], v[68:71]
  v_mfma_f32_16x16x32_bf16 v[72:75], a[212:215], v[88:91], v[72:75]
  v_mfma_f32_16x16x32_bf16 v[76:79], v[148:151], v[88:91], v[76:79]
  v_mfma_f32_16x16x32_bf16 v[80:83], v[212:215], v[88:91], v[80:83]
  ds_read_b128 v[88:91], v4 offset:7168
  s_waitcnt lgkmcnt(1)
  v_mfma_f32_16x16x32_bf16 v[60:63], a[24:27], v[84:87], v[60:63]
  v_mfma_f32_16x16x32_bf16 v[64:67], a[88:91], v[84:87], v[64:67]
  v_mfma_f32_16x16x32_bf16 v[68:71], a[152:155], v[84:87], v[68:71]
  v_mfma_f32_16x16x32_bf16 v[72:75], a[216:219], v[84:87], v[72:75]
  v_mfma_f32_16x16x32_bf16 v[76:79], v[152:155], v[84:87], v[76:79]
  v_mfma_f32_16x16x32_bf16 v[80:83], v[216:219], v[84:87], v[80:83]
  ds_read_b128 v[84:87], v4 offset:8192
  s_waitcnt lgkmcnt(1)
  v_mfma_f32_16x16x32_bf16 v[60:63], a[28:31], v[88:91], v[60:63]
  v_mfma_f32_16x16x32_bf16 v[64:67], a[92:95], v[88:91], v[64:67]
  v_mfma_f32_16x16x32_bf16 v[68:71], a[156:159], v[88:91], v[68:71]
  v_mfma_f32_16x16x32_bf16 v[72:75], a[220:223], v[88:91], v[72:75]
  v_mfma_f32_16x16x32_bf16 v[76:79], v[156:159], v[88:91], v[76:79]
  v_mfma_f32_16x16x32_bf16 v[80:83], v[220:223], v[88:91], v[80:83]
  ds_read_b128 v[88:91], v4 offset:9216
  s_waitcnt lgkmcnt(1)
  v_mfma_f32_16x16x32_bf16 v[60:63], a[32:35], v[84:87], v[60:63]
  v_mfma_f32_16x16x32_bf16 v[64:67], a[96:99], v[84:87], v[64:67]
  v_mfma_f32_16x16x32_bf16 v[68:71], a[160:163], v[84:87], v[68:71]
  v_mfma_f32_16x16x32_bf16 v[72:75], a[224:227], v[84:87], v[72:75]
  v_mfma_f32_16x16x32_bf16 v[76:79], v[160:163], v[84:87], v[76:79]
  v_mfma_f32_16x16x32_bf16 v[80:83], v[224:227], v[84:87], v[80:83]
  ds_read_b128 v[84:87], v4 offset:10240
  s_waitcnt lgkmcnt(1)
  v_mfma_f32_16x16x32_bf16 v[60:63], a[36:39], v[88:91], v[60:63]
  v_mfma_f32_16x16x32_bf16 v[64:67], a[100:103], v[88:91], v[64:67]
  v_mfma_f32_16x16x32_bf16 v[68:71], a[164:167], v[88:91], v[68:71]
  v_mfma_f32_16x16x32_bf16 v[72:75], a[228:231], v[88:91], v[72:75]
  v_mfma_f32_16x16x32_bf16 v[76:79], v[164:167], v[88:91], v[76:79]
  v_mfma_f32_16x16x32_bf16 v[80:83], v[228:231], v[88:91], v[80:83]
  ds_read_b128 v[88:91], v4 offset:11264
  s_waitcnt lgkmcnt(1)
  v_mfma_f32_16x16x32_bf16 v[60:63], a[40:43], v[84:87], v[60:63]
  v_mfma_f32_16x16x32_bf16 v[64:67], a[104:107], v[84:87], v[64:67]
  v_mfma_f32_16x16x32_bf16 v[68:71], a[168:171], v[84:87], v[68:71]
  v_mfma_f32_16x16x32_bf16 v[72:75], a[232:235], v[84:87], v[72:75]
  v_mfma_f32_16x16x32_bf16 v[76:79], v[168:171], v[84:87], v[76:79]
  v_mfma_f32_16x16x32_bf16 v[80:83], v[232:235], v[84:87], v[80:83]
  ds_read_b128 v[84:87], v4 offset:12288
  s_waitcnt lgkmcnt(1)
  v_mfma_f32_16x16x32_bf16 v[60:63], a[44:47], v[88:91], v[60:63]
  v_mfma_f32_16x16x32_bf16 v[64:67], a[108:111], v[88:91], v[64:67]
  v_mfma_f32_16x16x32_bf16 v[68:71], a[172:175], v[88:91], v[68:71]
  v_mfma_f32_16x16x32_bf16 v[72:75], a[236:239], v[88:91], v[72:75]
  v_mfma_f32_16x16x32_bf16 v[76:79], v[172:175], v[88:91], v[76:79]
  v_mfma_f32_16x16x32_bf16 v[80:83], v[236:239], v[88:91], v[80:83]
  ds_read_b128 v[88:91], v4 offset:13312
  s_waitcnt lgkmcnt(1)
  v_mfma_f32_16x16x32_bf16 v[60:63], a[48:51], v[84:87], v[60:63]
  v_mfma_f32_16x16x32_bf16 v[64:67], a[112:115], v[84:87], v[64:67]
  v_mfma_f32_16x16x32_bf16 v[68:71], a[176:179], v[84:87], v[68:71]
  v_mfma_f32_16x16x32_bf16 v[72:75], a[240:243], v[84:87], v[72:75]
  v_mfma_f32_16x16x32_bf16 v[76:79], v[176:179], v[84:87], v[76:79]
  v_mfma_f32_16x16x32_bf16 v[80:83], v[240:243], v[84:87], v[80:83]
  ds_read_b128 v[84:87], v4 offset:14336
  s_waitcnt lgkmcnt(1)
  v_mfma_f32_16x16x32_bf16 v[60:63], a[52:55], v[88:91], v[60:63]
  v_mfma_f32_16x16x32_bf16 v[64:67], a[116:119], v[88:91], v[64:67]
  v_mfma_f32_16x16x32_bf16 v[68:71], a[180:183], v[88:91], v[68:71]
  v_mfma_f32_16x16x32_bf16 v[72:75], a[244:247], v[88:91], v[72:75]
  v_mfma_f32_16x16x32_bf16 v[76:79], v[180:183], v[88:91], v[76:79]
  v_mfma_f32_16x16x32_bf16 v[80:83], v[244:247], v[88:91], v[80:83]
  ds_read_b128 v[88:91], v4 offset:15360
  s_waitcnt lgkmcnt(1)
  v_mfma_f32_16x16x32_bf16 v[60:63], a[56:59], v[84:87], v[60:63]
  v_mfma_f32_16x16x32_bf16 v[64:67], a[120:123], v[84:87], v[64:67]
  v_mfma_f32_16x16x32_bf16 v[68:71], a[184:187], v[84:87], v[68:71]
  v_mfma_f32_16x16x32_bf16 v[72:75], a[248:251], v[84:87], v[72:75]
  v_mfma_f32_16x16x32_bf16 v[76:79], v[184:187], v[84:87], v[76:79]
  v_mfma_f32_16x16x32_bf16 v[80:83], v[248:251], v[84:87], v[80:83]
  s_waitcnt lgkmcnt(0)
  v_mfma_f32_16x16x32_bf16 v[60:63], a[60:63], v[88:91], v[60:63]
  v_mfma_f32_16x16x32_bf16 v[64:67], a[124:127], v[88:91], v[64:67]
  v_mfma_f32_16x16x32_bf16 v[68:71], a[188:191], v[88:91], v[68:71]
  v_mfma_f32_16x16x32_bf16 v[72:75], a[252:255], v[88:91], v[72:75]
  v_mfma_f32_16x16x32_bf16 v[76:79], v[188:191], v[88:91], v[76:79]
  v_mfma_f32_16x16x32_bf16 v[80:83], v[252:255], v[88:91], v[80:83]
  s_nop 7
  s_nop 3
  v_cvt_pk_bf16_f32 v92, v60, v61
  v_cvt_pk_bf16_f32 v93, v62, v63
  v_cvt_pk_bf16_f32 v94, v64, v65
  v_cvt_pk_bf16_f32 v95, v66, v67
  s_mov_b64 exec, s[26:27]
  ds_write_b64 v5, v[92:93] offset:16384
  ds_write_b64 v5, v[94:95] offset:16896
  s_mov_b64 exec, -1
  v_cvt_pk_bf16_f32 v92, v68, v69
  v_cvt_pk_bf16_f32 v93, v70, v71
  v_cvt_pk_bf16_f32 v94, v72, v73
  v_cvt_pk_bf16_f32 v95, v74, v75
  s_mov_b64 exec, s[26:27]
  ds_write_b64 v5, v[92:93] offset:20480
  ds_write_b64 v5, v[94:95] offset:20992
  buffer_store_dwordx2 v[92:93], v8, s[4:7], s21 offen
  buffer_store_dwordx2 v[94:95], v8, s[4:7], s21 offen offset:32
  s_mov_b64 exec, -1
  v_cvt_pk_bf16_f32 v92, v76, v77
  v_cvt_pk_bf16_f32 v93, v78, v79
  v_cvt_pk_bf16_f32 v94, v80, v81
  v_cvt_pk_bf16_f32 v95, v82, v83
  s_mov_b64 exec, s[26:27]
  ds_write_b16 v6, v92 offset:0
  buffer_store_short v92, v9, s[4:7], s22 offen offset:0
  ds_write_b16_d16_hi v6, v92 offset:32
  buffer_store_short_d16_hi v92, v9, s[4:7], s22 offen offset:16
  ds_write_b16 v6, v93 offset:64
  buffer_store_short v93, v9, s[4:7], s22 offen offset:32
  ds_write_b16_d16_hi v6, v93 offset:96
  buffer_store_short_d16_hi v93, v9, s[4:7], s22 offen offset:48
  ds_write_b16 v6, v94 offset:512
  buffer_store_short v94, v9, s[4:7], s22 offen offset:256
  ds_write_b16_d16_hi v6, v94 offset:544
  buffer_store_short_d16_hi v94, v9, s[4:7], s22 offen offset:272
  ds_write_b16 v6, v95 offset:576
  buffer_store_short v95, v9, s[4:7], s22 offen offset:288
  ds_write_b16_d16_hi v6, v95 offset:608
  buffer_store_short_d16_hi v95, v9, s[4:7], s22 offen offset:304
  s_mov_b64 exec, -1
  s_cmp_eq_u32 s18, 63
  s_cbranch_scc1 .Lchain_kernel_fin4
  s_waitcnt lgkmcnt(0)
  s_barrier
  v_mov_b32 v76, 0
  v_mov_b32 v77, 0
  v_mov_b32 v78, 0
  v_mov_b32 v79, 0
  v_mov_b32 v80, 0
  v_mov_b32 v81, 0
  v_mov_b32 v82, 0
  v_mov_b32 v83, 0
  v_mov_b32 v84, 0
  v_mov_b32 v85, 0
  v_mov_b32 v86, 0
  v_mov_b32 v87, 0
  ds_read_b128 v[60:63], v4 offset:16384
  ds_read_b128 v[68:71], v4 offset:20480
  s_waitcnt vmcnt(0)
  ds_read_b128 v[64:67], v4 offset:17408
  ds_read_b128 v[72:75], v4 offset:21504
  s_waitcnt lgkmcnt(2)
  v_mfma_f32_16x16x32_bf16 v[76:79], v[68:71], v[60:63], v[76:79]
  v_mfma_f32_16x16x32_bf16 v[80:83], v[20:23], v[60:63], v[80:83]
  v_mfma_f32_16x16x32_bf16 v[84:87], v[36:39], v[60:63], v[84:87]
  ds_read_b128 v[60:63], v4 offset:18432
  ds_read_b128 v[68:71], v4 offset:22528
  s_waitcnt lgkmcnt(2)
  v_mfma_f32_16x16x32_bf16 v[76:79], v[72:75], v[64:67], v[76:79]
  v_mfma_f32_16x16x32_bf16 v[80:83], v[24:27], v[64:67], v[80:83]
  v_mfma_f32_16x16x32_bf16 v[84:87], v[40:43], v[64:67], v[84:87]
  ds_read_b128 v[64:67], v4 offset:19456
  ds_read_b128 v[72:75], v4 offset:23552
  s_waitcnt lgkmcnt(2)
  v_mfma_f32_16x16x32_bf16 v[76:79], v[68:71], v[60:63], v[76:79]
  v_mfma_f32_16x16x32_bf16 v[80:83], v[28:31], v[60:63], v[80:83]
  v_mfma_f32_16x16x32_bf16 v[84:87], v[44:47], v[60:63], v[84:87]
  s_waitcnt lgkmcnt(0)
  v_mfma_f32_16x16x32_bf16 v[76:79], v[72:75], v[64:67], v[76:79]
  v_mfma_f32_16x16x32_bf16 v[80:83], v[32:35], v[64:67], v[80:83]
  v_mfma_f32_16x16x32_bf16 v[84:87], v[48:51], v[64:67], v[84:87]
  ds_read_b64 v[108:109], v7
  ds_read_b64 v[112:113], v7 offset:512
  s_nop 7
  v_cvt_pk_bf16_f32 v92, v76, v77
  v_cvt_pk_bf16_f32 v93, v78, v79
  v_cvt_pk_bf16_f32 v94, v80, v81
  v_cvt_pk_bf16_f32 v95, v82, v83
  v_cvt_pk_bf16_f32 v96, v84, v85
  v_cvt_pk_bf16_f32 v97, v86, v87
  v_lshlrev_b32 v76, 16, v92
  v_and_b32 v77, 0xffff0000, v92
  v_lshlrev_b32 v78, 16, v93
  v_and_b32 v79, 0xffff0000, v93
  v_lshlrev_b32 v80, 16, v94
  v_and_b32 v81, 0xffff0000, v94
  v_lshlrev_b32 v82, 16, v95
  v_and_b32 v83, 0xffff0000, v95
  v_lshlrev_b32 v84, 16, v96
  v_and_b32 v85, 0xffff0000, v96
  v_lshlrev_b32 v86, 16, v97
  v_and_b32 v87, 0xffff0000, v97
  v_mul_f32 v76, s32, v76
  v_mul_f32 v77, s32, v77
  v_mul_f32 v78, s32, v78
  v_mul_f32 v79, s32, v79
  v_mul_f32 v80, s32, v80
  v_mul_f32 v81, s32, v81
  v_mul_f32 v82, s32, v82
  v_mul_f32 v83, s32, v83
  v_mul_f32 v84, s32, v84
  v_mul_f32 v85, s32, v85
  v_mul_f32 v86, s32, v86
  v_mul_f32 v87, s32, v87
  v_cvt_pk_bf16_f32 v92, v76, v77
  v_cvt_pk_bf16_f32 v93, v78, v79
  v_cvt_pk_bf16_f32 v94, v80, v81
  v_cvt_pk_bf16_f32 v95, v82, v83
  v_cvt_pk_bf16_f32 v96, v84, v85
  v_cvt_pk_bf16_f32 v97, v86, v87
  v_lshlrev_b32 v76, 16, v92
  v_and_b32 v77, 0xffff0000, v92
  v_lshlrev_b32 v78, 16, v93
  v_and_b32 v79, 0xffff0000, v93
  v_lshlrev_b32 v80, 16, v94
  v_and_b32 v81, 0xffff0000, v94
  v_lshlrev_b32 v82, 16, v95
  v_and_b32 v83, 0xffff0000, v95
  v_lshlrev_b32 v84, 16, v96
  v_and_b32 v85, 0xffff0000, v96
  v_lshlrev_b32 v86, 16, v97
  v_and_b32 v87, 0xffff0000, v97
  v_mov_b32 v124, 0xff800000
  v_cndmask_b32 v76, v124, v76, s[28:29]
  v_cndmask_b32 v77, v124, v77, s[28:29]
  v_cndmask_b32 v78, v124, v78, s[28:29]
  v_cndmask_b32 v79, v124, v79, s[28:29]
  v_max3_f32 v125, v76, v77, v78
  v_max3_f32 v125, v125, v79, v80
  v_max3_f32 v125, v125, v81, v82
  v_max3_f32 v125, v125, v83, v84
  v_max3_f32 v125, v125, v85, v86
  v_max_f32 v125, v125, v87
  v_mov_b32 v126, v125
  s_nop 1
  v_permlane16_swap_b32 v125, v126
  v_max_f32 v125, v125, v126
  v_mov_b32 v126, v125
  s_nop 1
  v_permlane32_swap_b32 v125, v126
  v_max_f32 v125, v125, v126
  v_mul_f32 v125, s33, v125
  v_fma_f32 v76, v76, s33, -v125
  v_fma_f32 v77, v77, s33, -v125
  v_fma_f32 v78, v78, s33, -v125
  v_fma_f32 v79, v79, s33, -v125
  v_fma_f32 v80, v80, s33, -v125
  v_fma_f32 v81, v81, s33, -v125
  v_fma_f32 v82, v82, s33, -v125
  v_fma_f32 v83, v83, s33, -v125
  v_fma_f32 v84, v84, s33, -v125
  v_fma_f32 v85, v85, s33, -v125
  v_fma_f32 v86, v86, s33, -v125
  v_fma_f32 v87, v87, s33, -v125
  v_exp_f32 v76, v76
  v_exp_f32 v77, v77
  v_exp_f32 v78, v78
  v_exp_f32 v79, v79
  v_exp_f32 v80, v80
  v_exp_f32 v81, v81
  v_exp_f32 v82, v82
  v_exp_f32 v83, v83
  v_exp_f32 v84, v84
  v_exp_f32 v85, v85
  v_exp_f32 v86, v86
  v_exp_f32 v87, v87
  s_nop 0
  v_add_f32 v125, v76, v77
  v_add_f32 v125, v125, v78
  v_add_f32 v125, v125, v79
  v_add_f32 v125, v125, v80
  v_add_f32 v125, v125, v81
  v_add_f32 v125, v125, v82
  v_add_f32 v125, v125, v83
  v_add_f32 v125, v125, v84
  v_add_f32 v125, v125, v85
  v_add_f32 v125, v125, v86
  v_add_f32 v125, v125, v87
  v_mov_b32 v126, v125
  s_nop 1
  v_permlane16_swap_b32 v125, v126
  v_add_f32 v125, v125, v126
  v_mov_b32 v126, v125
  s_nop 1
  v_permlane32_swap_b32 v125, v126
  v_add_f32 v125, v125, v126
  v_rcp_f32 v126, v125
  s_nop 0
  v_fma_f32 v127, -v125, v126, 1.0
  v_fma_f32 v126, v127, v126, v126
  v_mul_f32 v76, v76, v126
  v_mul_f32 v77, v77, v126
  v_mul_f32 v78, v78, v126
  v_mul_f32 v79, v79, v126
  v_mul_f32 v80, v80, v126
  v_mul_f32 v81, v81, v126
  v_mul_f32 v82, v82, v126
  v_mul_f32 v83, v83, v126
  v_mul_f32 v84, v84, v126
  v_mul_f32 v85, v85, v126
  v_mul_f32 v86, v86, v126
  v_mul_f32 v87, v87, v126
  v_cvt_pk_bf16_f32 v100, v80, v81
  v_cvt_pk_bf16_f32 v101, v82, v83
  v_cvt_pk_bf16_f32 v102, v84, v85
  v_cvt_pk_bf16_f32 v103, v86, v87
  v_cvt_pk_bf16_f32 v104, v76, v77
  v_cvt_pk_bf16_f32 v105, v78, v79
  v_mov_b32 v106, 0
  v_mov_b32 v107, 0
  v_mov_b32 v110, 0
  v_mov_b32 v111, 0
  v_mov_b32 v114, 0
  v_mov_b32 v115, 0
  s_waitcnt lgkmcnt(0)
  s_nop 1
  v_mfma_f32_16x16x32_bf16 v[116:119], v[52:55], v[100:103], 0
  v_mfma_f32_16x16x32_bf16 v[116:119], v[108:111], v[104:107], v[116:119]
  v_mfma_f32_16x16x32_bf16 v[120:123], v[56:59], v[100:103], 0
  v_mfma_f32_16x16x32_bf16 v[120:123], v[112:115], v[104:107], v[120:123]
  s_nop 7
  s_nop 1
  v_cvt_pk_bf16_f32 v92, v116, v117
  v_cvt_pk_bf16_f32 v93, v118, v119
  v_cvt_pk_bf16_f32 v94, v120, v121
  v_cvt_pk_bf16_f32 v95, v122, v123
  s_mov_b64 exec, s[26:27]
  ds_write_b64 v5, v[92:93] offset:0
  ds_write_b64 v5, v[94:95] offset:512
  s_mov_b64 exec, -1
  s_waitcnt lgkmcnt(0)
  s_barrier
  v_mov_b32 v20, 0
  v_mov_b32 v21, 0
  v_mov_b32 v22, 0
  v_mov_b32 v23, 0
  v_mov_b32 v24, 0
  v_mov_b32 v25, 0
  v_mov_b32 v26, 0
  v_mov_b32 v27, 0
  v_mov_b32 v28, 0
  v_mov_b32 v29, 0
  v_mov_b32 v30, 0
  v_mov_b32 v31, 0
  v_mov_b32 v32, 0
  v_mov_b32 v33, 0
  v_mov_b32 v34, 0
  v_mov_b32 v35, 0
  v_mov_b32 v36, 0
  v_mov_b32 v37, 0
  v_mov_b32 v38, 0
  v_mov_b32 v39, 0
  v_mov_b32 v40, 0
  v_mov_b32 v41, 0
  v_mov_b32 v42, 0
  v_mov_b32 v43, 0
  v_mov_b32 v44, 0
  v_mov_b32 v45, 0
  v_mov_b32 v46, 0
  v_mov_b32 v47, 0
  v_mov_b32 v48, 0
  v_mov_b32 v49, 0
  v_mov_b32 v50, 0
  v_mov_b32 v51, 0
  ds_read_b128 v[60:63], v4 offset:0
  ds_read_b128 v[64:67], v4 offset:1024
  ds_read_b128 v[68:71], v4 offset:2048
  ds_read_b128 v[72:75], v4 offset:3072
  ds_read_b128 v[76:79], v18 offset:0
  ds_read_b128 v[80:83], v18 offset:1024
  ds_read_b128 v[84:87], v18 offset:2048
  ds_read_b128 v[88:91], v18 offset:3072
  s_waitcnt lgkmcnt(3)
  v_mfma_f32_16x16x32_bf16 v[20:23], v[60:63], v[76:79], v[20:23]
  ds_read_b128 v[76:79], v18 offset:4096
  s_waitcnt lgkmcnt(3)
  v_mfma_f32_16x16x32_bf16 v[20:23], v[64:67], v[80:83], v[20:23]
  ds_read_b128 v[80:83], v18 offset:5120
  s_waitcnt lgkmcnt(3)
  v_mfma_f32_16x16x32_bf16 v[20:23], v[68:71], v[84:87], v[20:23]
  ds_read_b128 v[84:87], v18 offset:6144
  s_waitcnt lgkmcnt(3)
  v_mfma_f32_16x16x32_bf16 v[20:23], v[72:75], v[88:91], v[20:23]
  ds_read_b128 v[88:91], v18 offset:7168
  s_waitcnt lgkmcnt(3)
  v_mfma_f32_16x16x32_bf16 v[24:27], v[60:63], v[76:79], v[24:27]
  ds_read_b128 v[76:79], v18 offset:8192
  s_waitcnt lgkmcnt(3)
  v_mfma_f32_16x16x32_bf16 v[24:27], v[64:67], v[80:83], v[24:27]
  ds_read_b128 v[80:83], v18 offset:9216
  s_waitcnt lgkmcnt(3)
  v_mfma_f32_16x16x32_bf16 v[24:27], v[68:71], v[84:87], v[24:27]
  ds_read_b128 v[84:87], v18 offset:10240
  s_waitcnt lgkmcnt(3)
  v_mfma_f32_16x16x32_bf16 v[24:27], v[72:75], v[88:91], v[24:27]
  ds_read_b128 v[88:91], v18 offset:11264
  s_waitcnt lgkmcnt(3)
  v_mfma_f32_16x16x32_bf16 v[28:31], v[60:63], v[76:79], v[28:31]
  ds_read_b128 v[76:79], v18 offset:12288
  s_waitcnt lgkmcnt(3)
  v_mfma_f32_16x16x32_bf16 v[28:31], v[64:67], v[80:83], v[28:31]
  ds_read_b128 v[80:83], v18 offset:13312
  s_waitcnt lgkmcnt(3)
  v_mfma_f32_16x16x32_bf16 v[28:31], v[68:71], v[84:87], v[28:31]
  ds_read_b128 v[84:87], v18 offset:14336
  s_waitcnt lgkmcnt(3)
  v_mfma_f32_16x16x32_bf16 v[28:31], v[72:75], v[88:91], v[28:31]
  ds_read_b128 v[88:91], v18 offset:15360
  s_waitcnt lgkmcnt(3)
  v_mfma_f32_16x16x32_bf16 v[32:35], v[60:63], v[76:79], v[32:35]
  ds_read_b128 v[76:79], v18 offset:16384
  s_waitcnt lgkmcnt(3)
  v_mfma_f32_16x16x32_bf16 v[32:35], v[64:67], v[80:83], v[32:35]
  ds_read_b128 v[80:83], v18 offset:17408
  s_waitcnt lgkmcnt(3)
  v_mfma_f32_16x16x32_bf16 v[32:35], v[68:71], v[84:87], v[32:35]
  ds_read_b128 v[84:87], v18 offset:18432
  s_waitcnt lgkmcnt(3)
  v_mfma_f32_16x16x32_bf16 v[32:35], v[72:75], v[88:91], v[32:35]
  ds_read_b128 v[88:91], v18 offset:19456
  s_waitcnt lgkmcnt(3)
  v_mfma_f32_16x16x32_bf16 v[36:39], v[60:63], v[76:79], v[36:39]
  ds_read_b128 v[76:79], v18 offset:20480
  s_waitcnt lgkmcnt(3)
  v_mfma_f32_16x16x32_bf16 v[36:39], v[64:67], v[80:83], v[36:39]
  ds_read_b128 v[80:83], v18 offset:21504
  s_waitcnt lgkmcnt(3)
  v_mfma_f32_16x16x32_bf16 v[36:39], v[68:71], v[84:87], v[36:39]
  ds_read_b128 v[84:87], v18 offset:22528
  s_waitcnt lgkmcnt(3)
  v_mfma_f32_16x16x32_bf16 v[36:39], v[72:75], v[88:91], v[36:39]
  ds_read_b128 v[88:91], v18 offset:23552
  s_waitcnt lgkmcnt(3)
  v_mfma_f32_16x16x32_bf16 v[40:43], v[60:63], v[76:79], v[40:43]
  ds_read_b128 v[76:79], v18 offset:24576
  s_waitcnt lgkmcnt(3)
  v_mfma_f32_16x16x32_bf16 v[40:43], v[64:67], v[80:83], v[40:43]
  ds_read_b128 v[80:83], v18 offset:25600
  s_waitcnt lgkmcnt(3)
  v_mfma_f32_16x16x32_bf16 v[40:43], v[68:71], v[84:87], v[40:43]
  ds_read_b128 v[84:87], v18 offset:26624
  s_waitcnt lgkmcnt(3)
  v_mfma_f32_16x16x32_bf16 v[40:43], v[72:75], v[88:91], v[40:43]
  ds_read_b128 v[88:91], v18 offset:27648
  s_waitcnt lgkmcnt(3)
  v_mfma_f32_16x16x32_bf16 v[44:47], v[60:63], v[76:79], v[44:47]
  ds_read_b128 v[76:79], v18 offset:28672
  s_waitcnt lgkmcnt(3)
  v_mfma_f32_16x16x32_bf16 v[44:47], v[64:67], v[80:83], v[44:47]
  ds_read_b128 v[80:83], v18 offset:29696
  s_waitcnt lgkmcnt(3)
  v_mfma_f32_16x16x32_bf16 v[44:47], v[68:71], v[84:87], v[44:47]
  ds_read_b128 v[84:87], v18 offset:30720
  s_waitcnt lgkmcnt(3)
  v_mfma_f32_16x16x32_bf16 v[44:47], v[72:75], v[88:91], v[44:47]
  ds_read_b128 v[88:91], v18 offset:31744
  s_waitcnt lgkmcnt(3)
  v_mfma_f32_16x16x32_bf16 v[48:51], v[60:63], v[76:79], v[48:51]
  s_waitcnt lgkmcnt(2)
  v_mfma_f32_16x16x32_bf16 v[48:51], v[64:67], v[80:83], v[48:51]
  s_waitcnt lgkmcnt(1)
  v_mfma_f32_16x16x32_bf16 v[48:51], v[68:71], v[84:87], v[48:51]
  s_waitcnt lgkmcnt(0)
  v_mfma_f32_16x16x32_bf16 v[48:51], v[72:75], v[88:91], v[48:51]
  s_nop 7
  s_nop 3
  v_permlane32_swap_b32 v20, v36
  v_permlane32_swap_b32 v21, v37
  v_permlane32_swap_b32 v22, v38
  v_permlane32_swap_b32 v23, v39
  v_permlane32_swap_b32 v24, v40
  v_permlane32_swap_b32 v25, v41
  v_permlane32_swap_b32 v26, v42
  v_permlane32_swap_b32 v27, v43
  v_permlane32_swap_b32 v28, v44
  v_permlane32_swap_b32 v29, v45
  v_permlane32_swap_b32 v30, v46
  v_permlane32_swap_b32 v31, v47
  v_permlane32_swap_b32 v32, v48
  v_permlane32_swap_b32 v33, v49
  v_permlane32_swap_b32 v34, v50
  v_permlane32_swap_b32 v35, v51
  buffer_store_dword v20, v13, s[4:7], s23 offen offset:0
  buffer_store_dword v21, v13, s[4:7], s23 offen offset:64
  buffer_store_dword v22, v13, s[4:7], s23 offen offset:128
  buffer_store_dword v23, v13, s[4:7], s23 offen offset:192
  buffer_store_dword v24, v13, s[4:7], s23 offen offset:512
  buffer_store_dword v25, v13, s[4:7], s23 offen offset:576
  buffer_store_dword v26, v13, s[4:7], s23 offen offset:640
  buffer_store_dword v27, v13, s[4:7], s23 offen offset:704
  buffer_store_dword v28, v13, s[4:7], s23 offen offset:1024
  buffer_store_dword v29, v13, s[4:7], s23 offen offset:1088
  buffer_store_dword v30, v13, s[4:7], s23 offen offset:1152
  buffer_store_dword v31, v13, s[4:7], s23 offen offset:1216
  buffer_store_dword v32, v13, s[4:7], s23 offen offset:1536
  buffer_store_dword v33, v13, s[4:7], s23 offen offset:1600
  buffer_store_dword v34, v13, s[4:7], s23 offen offset:1664
  buffer_store_dword v35, v13, s[4:7], s23 offen offset:1728
  s_waitcnt vmcnt(0)
  s_barrier
  s_add_u32 s37, s18, 1
  s_mov_b32 s38, s24
  s_mov_b32 s40, s39
  s_cmp_eq_u32 s17, 0
  s_cbranch_scc0 .Lchain_kernel_not05
  v_mov_b32 v124, s37
  v_mov_b32 v125, s16
  v_lshlrev_b32 v125, 2, v125
  s_mov_b32 s34, 0x6230000
  s_mov_b64 exec, 1
  buffer_store_dword v124, v125, s[4:7], s34 offen
  s_mov_b64 exec, s[28:29]
  .Lchain_kernel_p16:
  buffer_load_dword v126, v17, s[4:7], s34 offen sc1
  s_waitcnt vmcnt(0)
  v_cmp_gt_u32 vcc, s37, v126
  s_cbranch_vccnz .Lchain_kernel_p16
  s_mov_b64 exec, -1
  buffer_load_dwordx4 v[60:63], v14, s[4:7], s38 offen sc1
  s_add_u32 s38, s38, 0x8000
  buffer_load_dwordx4 v[64:67], v14, s[4:7], s38 offen sc1
  s_add_u32 s38, s38, 0x8000
  buffer_load_dwordx4 v[68:71], v14, s[4:7], s38 offen sc1
  s_add_u32 s38, s38, 0x8000
  buffer_load_dwordx4 v[72:75], v14, s[4:7], s38 offen sc1
  s_add_u32 s38, s38, 0x8000
  buffer_load_dwordx4 v[76:79], v14, s[4:7], s38 offen sc1
  s_add_u32 s38, s38, 0x8000
  buffer_load_dwordx4 v[80:83], v14, s[4:7], s38 offen sc1
  s_add_u32 s38, s38, 0x8000
  buffer_load_dwordx4 v[84:87], v14, s[4:7], s38 offen sc1
  s_add_u32 s38, s38, 0x8000
  buffer_load_dwordx4 v[88:91], v14, s[4:7], s38 offen sc1
  s_add_u32 s38, s38, 0x8000
  buffer_load_dwordx4 v[92:95], v14, s[4:7], s38 offen sc1
  s_add_u32 s38, s38, 0x8000
  buffer_load_dwordx4 v[96:99], v14, s[4:7], s38 offen sc1
  s_add_u32 s38, s38, 0x8000
  buffer_load_dwordx4 v[100:103], v14, s[4:7], s38 offen sc1
  s_add_u32 s38, s38, 0x8000
  buffer_load_dwordx4 v[104:107], v14, s[4:7], s38 offen sc1
  s_add_u32 s38, s38, 0x8000
  buffer_load_dwordx4 v[108:111], v14, s[4:7], s38 offen sc1
  s_add_u32 s38, s38, 0x8000
  buffer_load_dwordx4 v[112:115], v14, s[4:7], s38 offen sc1
  s_add_u32 s38, s38, 0x8000
  buffer_load_dwordx4 v[116:119], v14, s[4:7], s38 offen sc1
  s_add_u32 s38, s38, 0x8000
  buffer_load_dwordx4 v[120:123], v14, s[4:7], s38 offen sc1
  s_waitcnt vmcnt(14)
  v_add_f32 v60, v60, v64
  v_add_f32 v61, v61, v65
  v_add_f32 v62, v62, v66
  v_add_f32 v63, v63, v67
  s_waitcnt vmcnt(13)
  v_add_f32 v60, v60, v68
  v_add_f32 v61, v61, v69
  v_add_f32 v62, v62, v70
  v_add_f32 v63, v63, v71
  s_waitcnt vmcnt(12)
  v_add_f32 v60, v60, v72
  v_add_f32 v61, v61, v73
  v_add_f32 v62, v62, v74
  v_add_f32 v63, v63, v75
  s_waitcnt vmcnt(11)
  v_add_f32 v60, v60, v76
  v_add_f32 v61, v61, v77
  v_add_f32 v62, v62, v78
  v_add_f32 v63, v63, v79
  s_waitcnt vmcnt(10)
  v_add_f32 v60, v60, v80
  v_add_f32 v61, v61, v81
  v_add_f32 v62, v62, v82
  v_add_f32 v63, v63, v83
  s_waitcnt vmcnt(9)
  v_add_f32 v60, v60, v84
  v_add_f32 v61, v61, v85
  v_add_f32 v62, v62, v86
  v_add_f32 v63, v63, v87
  s_waitcnt vmcnt(8)
  v_add_f32 v60, v60, v88
  v_add_f32 v61, v61, v89
  v_add_f32 v62, v62, v90
  v_add_f32 v63, v63, v91
  s_waitcnt vmcnt(7)
  v_add_f32 v60, v60, v92
  v_add_f32 v61, v61, v93
  v_add_f32 v62, v62, v94
  v_add_f32 v63, v63, v95
  s_waitcnt vmcnt(6)
  v_add_f32 v60, v60, v96
  v_add_f32 v61, v61, v97
  v_add_f32 v62, v62, v98
  v_add_f32 v63, v63, v99
  s_waitcnt vmcnt(5)
  v_add_f32 v60, v60, v100
  v_add_f32 v61, v61, v101
  v_add_f32 v62, v62, v102
  v_add_f32 v63, v63, v103
  s_waitcnt vmcnt(4)
  v_add_f32 v60, v60, v104
  v_add_f32 v61, v61, v105
  v_add_f32 v62, v62, v106
  v_add_f32 v63, v63, v107
  s_waitcnt vmcnt(3)
  v_add_f32 v60, v60, v108
  v_add_f32 v61, v61, v109
  v_add_f32 v62, v62, v110
  v_add_f32 v63, v63, v111
  s_waitcnt vmcnt(2)
  v_add_f32 v60, v60, v112
  v_add_f32 v61, v61, v113
  v_add_f32 v62, v62, v114
  v_add_f32 v63, v63, v115
  s_waitcnt vmcnt(1)
  v_add_f32 v60, v60, v116
  v_add_f32 v61, v61, v117
  v_add_f32 v62, v62, v118
  v_add_f32 v63, v63, v119
  s_waitcnt vmcnt(0)
  v_add_f32 v60, v60, v120
  v_add_f32 v61, v61, v121
  v_add_f32 v62, v62, v122
  v_add_f32 v63, v63, v123
  v_mov_b32 v64, v60
  v_mov_b32 v65, v61
  v_mov_b32 v66, v62
  v_mov_b32 v67, v63
  s_nop 1
  v_permlane32_swap_b32 v60, v64
  v_permlane32_swap_b32 v61, v65
  v_permlane32_swap_b32 v62, v66
  v_permlane32_swap_b32 v63, v67
  v_add_f32 v60, v60, v64
  v_add_f32 v61, v61, v65
  v_add_f32 v62, v62, v66
  v_add_f32 v63, v63, v67
  v_cvt_pk_bf16_f32 v64, v60, v61
  v_cvt_pk_bf16_f32 v65, v62, v63
  v_lshlrev_b32 v126, 3, v1
  s_lshl_b32 s34, s16, 8
  s_add_u32 s34, s34, s40
  s_mov_b64 exec, s[28:29]
  buffer_store_dwordx2 v[64:65], v126, s[4:7], s34 offen
  s_waitcnt vmcnt(0)
  s_mov_b32 s34, 0x6230100
  s_mov_b64 exec, 1
  buffer_store_dword v124, v125, s[4:7], s34 offen
  s_mov_b64 exec, s[28:29]
  .Lchain_kernel_p27:
  buffer_load_dword v126, v17, s[4:7], s34 offen sc1
  s_waitcnt vmcnt(0)
  v_cmp_gt_u32 vcc, s37, v126
  s_cbranch_vccnz .Lchain_kernel_p27
  s_mov_b64 exec, -1
  .Lchain_kernel_not05:
  s_add_u32 s18, s18, 1
  s_lshl_b32 s34, s18, 5
  s_add_u32 s34, s34, s16
  s_lshl_b32 s35, s34, 13
  s_add_u32 s19, s35, 0x2930000
  s_add_u32 s20, s35, 0x3930000
  s_lshl_b32 s35, s34, 11
  s_add_u32 s21, s35, 0x5930000
  s_add_u32 s22, s35, 0x5d30000
  s_and_b32 s35, s18, 1
  s_lshl_b32 s23, s35, 19
  s_add_u32 s23, s23, 0x6130000
  s_mov_b32 s24, s23
  s_lshl_b32 s36, s16, 9
  s_add_u32 s24, s24, s36
  s_lshl_b32 s36, s16, 14
  s_add_u32 s23, s23, s36
  s_lshl_b32 s39, s35, 13
  s_add_u32 s39, s39, 0x6232000
  s_barrier
  buffer_load_dwordx4 v[60:63], v15, s[4:7], s40 offen sc1
  v_add_u32 v127, 0x1000, v15
  buffer_load_dwordx4 v[64:67], v127, s[4:7], s40 offen sc1
  s_waitcnt vmcnt(1)
  ds_write_b128 v16, v[60:63]
  s_waitcnt vmcnt(0)
  ds_write_b128 v16, v[64:67] offset:8192
  buffer_load_dwordx4 v[20:23], v10, s[4:7], s19 offen offset:0
  buffer_load_dwordx4 v[24:27], v10, s[4:7], s19 offen offset:64
  buffer_load_dwordx4 v[28:31], v10, s[4:7], s19 offen offset:128
  buffer_load_dwordx4 v[32:35], v10, s[4:7], s19 offen offset:192
  buffer_load_dwordx4 v[36:39], v11, s[4:7], s19 offen offset:0
  buffer_load_dwordx4 v[40:43], v11, s[4:7], s19 offen offset:64
  buffer_load_dwordx4 v[44:47], v11, s[4:7], s19 offen offset:128
  buffer_load_dwordx4 v[48:51], v11, s[4:7], s19 offen offset:192
  buffer_load_dwordx2 v[52:53], v12, s[4:7], s20 offen offset:0
  buffer_load_dwordx2 v[54:55], v12, s[4:7], s20 offen offset:32
  buffer_load_dwordx2 v[56:57], v12, s[4:7], s20 offen offset:1024
  buffer_load_dwordx2 v[58:59], v12, s[4:7], s20 offen offset:1056
  s_waitcnt lgkmcnt(0)
  s_barrier
  s_branch .Lchain_kernel_step3
  .Lchain_kernel_fin4:
  s_waitcnt vmcnt(0)
  s_branch .Lchain_kernel_end1
  .Lchain_kernel_work2:
  s_cmp_eq_u32 s17, 0
  s_cbranch_scc0 .Lchain_kernel_work2_w
  v_mov_b32 v124, 1
  v_mov_b32 v125, 0
  s_mov_b32 s34, 0x6230800
  s_mov_b64 exec, 1
  buffer_atomic_add v124, v125, s[4:7], s34 offen sc0
  s_waitcnt vmcnt(0)
  v_mov_b32 v125, 0x20000
  ds_write_b32 v125, v124
  s_mov_b64 exec, -1
  .Lchain_kernel_work2_w:
  s_waitcnt lgkmcnt(0)
  s_barrier
  v_mov_b32 v125, 0x20000
  ds_read_b32 v124, v125
  s_waitcnt lgkmcnt(0)
  v_readfirstlane_b32 s44, v124
  .Lchain_kernel_wloop8:
  s_cmp_ge_u32 s44, 512
  s_cbranch_scc1 .Lchain_kernel_end1
  s_lshr_b32 s16, s44, 4
  s_and_b32 s17, s44, 15
  s_barrier
  v_and_b32 v1, 63, v0
  v_lshrrev_b32 v2, 6, v0
  v_and_b32 v3, 31, v0
  v_bfe_u32 v4, v0, 5, 1
  v_lshrrev_b32 v5, 3, v0
  v_and_b32 v6, 7, v0
  s_mul_i32 s18, s17, 131072
  s_add_u32 s18, s18, 0x1310000
  s_mul_i32 s19, s16, 131072
  s_add_u32 s19, s19, 0x110000
  s_mov_b32 s20, 1024
  v_mul_lo_u32 v7, v5, s20
  v_lshl_add_u32 v7, v6, 4, v7
  v_add_u32 v8, s18, v7
  v_add_u32 v9, s18, v7
  v_add_u32 v9, 0x8000, v9
  v_add_u32 v10, s18, v7
  v_add_u32 v10, 0x10000, v10
  v_add_u32 v11, s18, v7
  v_add_u32 v11, 0x18000, v11
  v_add_u32 v12, s19, v7
  v_add_u32 v13, s19, v7
  v_add_u32 v13, 0x8000, v13
  v_add_u32 v14, s19, v7
  v_add_u32 v14, 0x10000, v14
  v_add_u32 v15, s19, v7
  v_add_u32 v15, 0x18000, v15
  s_movk_i32 s21, 144
  v_mul_lo_u32 v16, v5, s21
  v_lshl_add_u32 v16, v6, 4, v16
  v_lshrrev_b32 v7, 1, v2
  v_mul_u32_u24 v7, 64, v7
  v_add_u32 v7, v7, v3
  v_mul_lo_u32 v17, v7, s21
  v_lshl_add_u32 v17, v4, 4, v17
  v_and_b32 v7, 1, v2
  v_mul_u32_u24 v7, 64, v7
  v_add_u32 v7, v7, v3
  v_mul_lo_u32 v18, v7, s21
  v_lshl_add_u32 v18, v4, 4, v18
  v_add_u32 v18, 18432, v18
  v_add_u32 v19, 36864, v16
  v_add_u32 v20, 36864, v17
  v_add_u32 v21, 36864, v18
  v_mov_b32 v120, 0
  v_mov_b32 v121, 0
  v_mov_b32 v122, 0
  v_mov_b32 v123, 0
  v_mov_b32 v124, 0
  v_mov_b32 v125, 0
  v_mov_b32 v126, 0
  v_mov_b32 v127, 0
  v_mov_b32 v128, 0
  v_mov_b32 v129, 0
  v_mov_b32 v130, 0
  v_mov_b32 v131, 0
  v_mov_b32 v132, 0
  v_mov_b32 v133, 0
  v_mov_b32 v134, 0
  v_mov_b32 v135, 0
  v_mov_b32 v136, 0
  v_mov_b32 v137, 0
  v_mov_b32 v138, 0
  v_mov_b32 v139, 0
  v_mov_b32 v140, 0
  v_mov_b32 v141, 0
  v_mov_b32 v142, 0
  v_mov_b32 v143, 0
  v_mov_b32 v144, 0
  v_mov_b32 v145, 0
  v_mov_b32 v146, 0
  v_mov_b32 v147, 0
  v_mov_b32 v148, 0
  v_mov_b32 v149, 0
  v_mov_b32 v150, 0
  v_mov_b32 v151, 0
  v_mov_b32 v152, 0
  v_mov_b32 v153, 0
  v_mov_b32 v154, 0
  v_mov_b32 v155, 0
  v_mov_b32 v156, 0
  v_mov_b32 v157, 0
  v_mov_b32 v158, 0
  v_mov_b32 v159, 0
  v_mov_b32 v160, 0
  v_mov_b32 v161, 0
  v_mov_b32 v162, 0
  v_mov_b32 v163, 0
  v_mov_b32 v164, 0
  v_mov_b32 v165, 0
  v_mov_b32 v166, 0
  v_mov_b32 v167, 0
  v_mov_b32 v168, 0
  v_mov_b32 v169, 0
  v_mov_b32 v170, 0
  v_mov_b32 v171, 0
  v_mov_b32 v172, 0
  v_mov_b32 v173, 0
  v_mov_b32 v174, 0
  v_mov_b32 v175, 0
  v_mov_b32 v176, 0
  v_mov_b32 v177, 0
  v_mov_b32 v178, 0
  v_mov_b32 v179, 0
  v_mov_b32 v180, 0
  v_mov_b32 v181, 0
  v_mov_b32 v182, 0
  v_mov_b32 v183, 0
  s_mov_b32 s18, 0
  buffer_load_dwordx4 v[24:27], v8, s[4:7], s18 offen
  buffer_load_dwordx4 v[28:31], v9, s[4:7], s18 offen
  buffer_load_dwordx4 v[32:35], v10, s[4:7], s18 offen
  buffer_load_dwordx4 v[36:39], v11, s[4:7], s18 offen
  buffer_load_dwordx4 v[40:43], v12, s[4:7], s18 offen
  buffer_load_dwordx4 v[44:47], v13, s[4:7], s18 offen
  buffer_load_dwordx4 v[48:51], v14, s[4:7], s18 offen
  buffer_load_dwordx4 v[52:55], v15, s[4:7], s18 offen
  s_movk_i32 s18, 128
  buffer_load_dwordx4 v[56:59], v8, s[4:7], s18 offen
  buffer_load_dwordx4 v[60:63], v9, s[4:7], s18 offen
  buffer_load_dwordx4 v[64:67], v10, s[4:7], s18 offen
  buffer_load_dwordx4 v[68:71], v11, s[4:7], s18 offen
  buffer_load_dwordx4 v[72:75], v12, s[4:7], s18 offen
  buffer_load_dwordx4 v[76:79], v13, s[4:7], s18 offen
  buffer_load_dwordx4 v[80:83], v14, s[4:7], s18 offen
  buffer_load_dwordx4 v[84:87], v15, s[4:7], s18 offen
  s_waitcnt vmcnt(8)
  ds_write_b128 v16, v[24:27] offset:0
  ds_write_b128 v16, v[28:31] offset:4608
  ds_write_b128 v16, v[32:35] offset:9216
  ds_write_b128 v16, v[36:39] offset:13824
  ds_write_b128 v16, v[40:43] offset:18432
  ds_write_b128 v16, v[44:47] offset:23040
  ds_write_b128 v16, v[48:51] offset:27648
  ds_write_b128 v16, v[52:55] offset:32256
  s_waitcnt lgkmcnt(0)
  s_barrier
  s_mov_b32 s22, 0
  .Lchain_kernel_loop9:
  s_add_u32 s18, s18, 128
  s_cmp_lt_u32 s22, 6
  s_cbranch_scc0 .Lchain_kernel_skl10
  buffer_load_dwordx4 v[24:27], v8, s[4:7], s18 offen
  buffer_load_dwordx4 v[28:31], v9, s[4:7], s18 offen
  buffer_load_dwordx4 v[32:35], v10, s[4:7], s18 offen
  buffer_load_dwordx4 v[36:39], v11, s[4:7], s18 offen
  buffer_load_dwordx4 v[40:43], v12, s[4:7], s18 offen
  buffer_load_dwordx4 v[44:47], v13, s[4:7], s18 offen
  buffer_load_dwordx4 v[48:51], v14, s[4:7], s18 offen
  buffer_load_dwordx4 v[52:55], v15, s[4:7], s18 offen
  .Lchain_kernel_skl10:
  ds_read_b128 v[88:91], v17 offset:0
  ds_read_b128 v[92:95], v17 offset:4608
  ds_read_b128 v[96:99], v18 offset:0
  ds_read_b128 v[100:103], v18 offset:4608
  ds_read_b128 v[104:107], v17 offset:32
  ds_read_b128 v[108:111], v17 offset:4640
  ds_read_b128 v[112:115], v18 offset:32
  ds_read_b128 v[116:119], v18 offset:4640
  s_waitcnt lgkmcnt(4)
  v_mfma_f32_32x32x16_bf16 v[120:135], v[96:99], v[88:91], v[120:135]
  v_mfma_f32_32x32x16_bf16 v[136:151], v[96:99], v[92:95], v[136:151]
  v_mfma_f32_32x32x16_bf16 v[152:167], v[100:103], v[88:91], v[152:167]
  v_mfma_f32_32x32x16_bf16 v[168:183], v[100:103], v[92:95], v[168:183]
  ds_read_b128 v[88:91], v17 offset:64
  ds_read_b128 v[92:95], v17 offset:4672
  ds_read_b128 v[96:99], v18 offset:64
  ds_read_b128 v[100:103], v18 offset:4672
  s_waitcnt lgkmcnt(4)
  v_mfma_f32_32x32x16_bf16 v[120:135], v[112:115], v[104:107], v[120:135]
  v_mfma_f32_32x32x16_bf16 v[136:151], v[112:115], v[108:111], v[136:151]
  v_mfma_f32_32x32x16_bf16 v[152:167], v[116:119], v[104:107], v[152:167]
  v_mfma_f32_32x32x16_bf16 v[168:183], v[116:119], v[108:111], v[168:183]
  ds_read_b128 v[104:107], v17 offset:96
  ds_read_b128 v[108:111], v17 offset:4704
  ds_read_b128 v[112:115], v18 offset:96
  ds_read_b128 v[116:119], v18 offset:4704
  s_waitcnt lgkmcnt(4)
  v_mfma_f32_32x32x16_bf16 v[120:135], v[96:99], v[88:91], v[120:135]
  v_mfma_f32_32x32x16_bf16 v[136:151], v[96:99], v[92:95], v[136:151]
  v_mfma_f32_32x32x16_bf16 v[152:167], v[100:103], v[88:91], v[152:167]
  v_mfma_f32_32x32x16_bf16 v[168:183], v[100:103], v[92:95], v[168:183]
  s_waitcnt lgkmcnt(0)
  v_mfma_f32_32x32x16_bf16 v[120:135], v[112:115], v[104:107], v[120:135]
  v_mfma_f32_32x32x16_bf16 v[136:151], v[112:115], v[108:111], v[136:151]
  v_mfma_f32_32x32x16_bf16 v[152:167], v[116:119], v[104:107], v[152:167]
  v_mfma_f32_32x32x16_bf16 v[168:183], v[116:119], v[108:111], v[168:183]
  s_cmp_lt_u32 s22, 7
  s_cbranch_scc0 .Lchain_kernel_sks11
  s_cmp_lt_u32 s22, 6
  s_cbranch_scc0 .Lchain_kernel_skw12
  s_waitcnt vmcnt(8)
  .Lchain_kernel_skw12:
  s_cmp_lt_u32 s22, 6
  s_cbranch_scc1 .Lchain_kernel_skv13
  s_waitcnt vmcnt(0)
  .Lchain_kernel_skv13:
  ds_write_b128 v19, v[56:59] offset:0
  ds_write_b128 v19, v[60:63] offset:4608
  ds_write_b128 v19, v[64:67] offset:9216
  ds_write_b128 v19, v[68:71] offset:13824
  ds_write_b128 v19, v[72:75] offset:18432
  ds_write_b128 v19, v[76:79] offset:23040
  ds_write_b128 v19, v[80:83] offset:27648
  ds_write_b128 v19, v[84:87] offset:32256
  .Lchain_kernel_sks11:
  s_waitcnt lgkmcnt(0)
  s_barrier
  s_add_u32 s18, s18, 128
  s_cmp_lt_u32 s22, 5
  s_cbranch_scc0 .Lchain_kernel_skl14
  buffer_load_dwordx4 v[56:59], v8, s[4:7], s18 offen
  buffer_load_dwordx4 v[60:63], v9, s[4:7], s18 offen
  buffer_load_dwordx4 v[64:67], v10, s[4:7], s18 offen
  buffer_load_dwordx4 v[68:71], v11, s[4:7], s18 offen
  buffer_load_dwordx4 v[72:75], v12, s[4:7], s18 offen
  buffer_load_dwordx4 v[76:79], v13, s[4:7], s18 offen
  buffer_load_dwordx4 v[80:83], v14, s[4:7], s18 offen
  buffer_load_dwordx4 v[84:87], v15, s[4:7], s18 offen
  .Lchain_kernel_skl14:
  ds_read_b128 v[88:91], v20 offset:0
  ds_read_b128 v[92:95], v20 offset:4608
  ds_read_b128 v[96:99], v21 offset:0
  ds_read_b128 v[100:103], v21 offset:4608
  ds_read_b128 v[104:107], v20 offset:32
  ds_read_b128 v[108:111], v20 offset:4640
  ds_read_b128 v[112:115], v21 offset:32
  ds_read_b128 v[116:119], v21 offset:4640
  s_waitcnt lgkmcnt(4)
  v_mfma_f32_32x32x16_bf16 v[120:135], v[96:99], v[88:91], v[120:135]
  v_mfma_f32_32x32x16_bf16 v[136:151], v[96:99], v[92:95], v[136:151]
  v_mfma_f32_32x32x16_bf16 v[152:167], v[100:103], v[88:91], v[152:167]
  v_mfma_f32_32x32x16_bf16 v[168:183], v[100:103], v[92:95], v[168:183]
  ds_read_b128 v[88:91], v20 offset:64
  ds_read_b128 v[92:95], v20 offset:4672
  ds_read_b128 v[96:99], v21 offset:64
  ds_read_b128 v[100:103], v21 offset:4672
  s_waitcnt lgkmcnt(4)
  v_mfma_f32_32x32x16_bf16 v[120:135], v[112:115], v[104:107], v[120:135]
  v_mfma_f32_32x32x16_bf16 v[136:151], v[112:115], v[108:111], v[136:151]
  v_mfma_f32_32x32x16_bf16 v[152:167], v[116:119], v[104:107], v[152:167]
  v_mfma_f32_32x32x16_bf16 v[168:183], v[116:119], v[108:111], v[168:183]
  ds_read_b128 v[104:107], v20 offset:96
  ds_read_b128 v[108:111], v20 offset:4704
  ds_read_b128 v[112:115], v21 offset:96
  ds_read_b128 v[116:119], v21 offset:4704
  s_waitcnt lgkmcnt(4)
  v_mfma_f32_32x32x16_bf16 v[120:135], v[96:99], v[88:91], v[120:135]
  v_mfma_f32_32x32x16_bf16 v[136:151], v[96:99], v[92:95], v[136:151]
  v_mfma_f32_32x32x16_bf16 v[152:167], v[100:103], v[88:91], v[152:167]
  v_mfma_f32_32x32x16_bf16 v[168:183], v[100:103], v[92:95], v[168:183]
  s_waitcnt lgkmcnt(0)
  v_mfma_f32_32x32x16_bf16 v[120:135], v[112:115], v[104:107], v[120:135]
  v_mfma_f32_32x32x16_bf16 v[136:151], v[112:115], v[108:111], v[136:151]
  v_mfma_f32_32x32x16_bf16 v[152:167], v[116:119], v[104:107], v[152:167]
  v_mfma_f32_32x32x16_bf16 v[168:183], v[116:119], v[108:111], v[168:183]
  s_cmp_lt_u32 s22, 6
  s_cbranch_scc0 .Lchain_kernel_sks15
  s_cmp_lt_u32 s22, 5
  s_cbranch_scc0 .Lchain_kernel_skw16
  s_waitcnt vmcnt(8)
  .Lchain_kernel_skw16:
  s_cmp_lt_u32 s22, 5
  s_cbranch_scc1 .Lchain_kernel_skv17
  s_waitcnt vmcnt(0)
  .Lchain_kernel_skv17:
  ds_write_b128 v16, v[24:27] offset:0
  ds_write_b128 v16, v[28:31] offset:4608
  ds_write_b128 v16, v[32:35] offset:9216
  ds_write_b128 v16, v[36:39] offset:13824
  ds_write_b128 v16, v[40:43] offset:18432
  ds_write_b128 v16, v[44:47] offset:23040
  ds_write_b128 v16, v[48:51] offset:27648
  ds_write_b128 v16, v[52:55] offset:32256
  .Lchain_kernel_sks15:
  s_waitcnt lgkmcnt(0)
  s_barrier
  s_add_u32 s22, s22, 2
  s_cmp_lt_u32 s22, 8
  s_cbranch_scc1 .Lchain_kernel_loop9
  s_nop 15
  v_lshrrev_b32 v184, 1, v2
  v_and_b32 v185, 1, v2
  s_and_b32 s24, s16, 31
  s_lshl_b32 s25, s17, 2
  v_lshlrev_b32 v186, 8, v3
  v_lshl_add_u32 v186, v185, 7, v186
  v_lshl_add_u32 v186, v4, 3, v186
  v_lshl_add_u32 v186, v184, 19, v186
  s_mov_b32 s26, 0x1930000
  s_mov_b32 s27, 0x2930000
  s_cmp_lt_u32 s16, 32
  s_cselect_b32 s26, s26, s27
  s_add_u32 s27, s25, 0
  s_lshl_b32 s27, s27, 5
  s_add_u32 s27, s27, s24
  s_lshl_b32 s27, s27, 13
  s_add_u32 s27, s27, s26
  s_add_u32 s28, s25, 1
  s_lshl_b32 s28, s28, 5
  s_add_u32 s28, s28, s24
  s_lshl_b32 s28, s28, 13
  s_add_u32 s28, s28, s26
  v_cvt_pk_bf16_f32 v188, v120, v121
  v_cvt_pk_bf16_f32 v189, v122, v123
  buffer_store_dwordx2 v[188:189], v186, s[4:7], s27 offen offset:0
  s_nop 0
  v_cvt_pk_bf16_f32 v188, v124, v125
  v_cvt_pk_bf16_f32 v189, v126, v127
  buffer_store_dwordx2 v[188:189], v186, s[4:7], s27 offen offset:16
  s_nop 0
  v_cvt_pk_bf16_f32 v188, v128, v129
  v_cvt_pk_bf16_f32 v189, v130, v131
  buffer_store_dwordx2 v[188:189], v186, s[4:7], s27 offen offset:32
  s_nop 0
  v_cvt_pk_bf16_f32 v188, v132, v133
  v_cvt_pk_bf16_f32 v189, v134, v135
  buffer_store_dwordx2 v[188:189], v186, s[4:7], s27 offen offset:48
  s_nop 0
  v_cvt_pk_bf16_f32 v188, v136, v137
  v_cvt_pk_bf16_f32 v189, v138, v139
  buffer_store_dwordx2 v[188:189], v186, s[4:7], s28 offen offset:0
  s_nop 0
  v_cvt_pk_bf16_f32 v188, v140, v141
  v_cvt_pk_bf16_f32 v189, v142, v143
  buffer_store_dwordx2 v[188:189], v186, s[4:7], s28 offen offset:16
  s_nop 0
  v_cvt_pk_bf16_f32 v188, v144, v145
  v_cvt_pk_bf16_f32 v189, v146, v147
  buffer_store_dwordx2 v[188:189], v186, s[4:7], s28 offen offset:32
  s_nop 0
  v_cvt_pk_bf16_f32 v188, v148, v149
  v_cvt_pk_bf16_f32 v189, v150, v151
  buffer_store_dwordx2 v[188:189], v186, s[4:7], s28 offen offset:48
  s_nop 0
  v_cvt_pk_bf16_f32 v188, v152, v153
  v_cvt_pk_bf16_f32 v189, v154, v155
  buffer_store_dwordx2 v[188:189], v186, s[4:7], s27 offen offset:64
  s_nop 0
  v_cvt_pk_bf16_f32 v188, v156, v157
  v_cvt_pk_bf16_f32 v189, v158, v159
  buffer_store_dwordx2 v[188:189], v186, s[4:7], s27 offen offset:80
  s_nop 0
  v_cvt_pk_bf16_f32 v188, v160, v161
  v_cvt_pk_bf16_f32 v189, v162, v163
  buffer_store_dwordx2 v[188:189], v186, s[4:7], s27 offen offset:96
  s_nop 0
  v_cvt_pk_bf16_f32 v188, v164, v165
  v_cvt_pk_bf16_f32 v189, v166, v167
  buffer_store_dwordx2 v[188:189], v186, s[4:7], s27 offen offset:112
  s_nop 0
  v_cvt_pk_bf16_f32 v188, v168, v169
  v_cvt_pk_bf16_f32 v189, v170, v171
  buffer_store_dwordx2 v[188:189], v186, s[4:7], s28 offen offset:64
  s_nop 0
  v_cvt_pk_bf16_f32 v188, v172, v173
  v_cvt_pk_bf16_f32 v189, v174, v175
  buffer_store_dwordx2 v[188:189], v186, s[4:7], s28 offen offset:80
  s_nop 0
  v_cvt_pk_bf16_f32 v188, v176, v177
  v_cvt_pk_bf16_f32 v189, v178, v179
  buffer_store_dwordx2 v[188:189], v186, s[4:7], s28 offen offset:96
  s_nop 0
  v_cvt_pk_bf16_f32 v188, v180, v181
  v_cvt_pk_bf16_f32 v189, v182, v183
  buffer_store_dwordx2 v[188:189], v186, s[4:7], s28 offen offset:112
  s_nop 0
  s_waitcnt vmcnt(0)
  s_add_u32 s44, s44, 224
  s_branch .Lchain_kernel_wloop8
  .Lchain_kernel_end1:
  s_endpgm

.globl attnb_kernel
.p2align 8
.type attnb_kernel,@function
attnb_kernel:
  s_cmp_ge_u32 s2, 512
  s_cbranch_scc1 .Lattnb_kernel_end1
  s_load_dwordx2 s[4:5], s[0:1], 112
  v_lshrrev_b32 v1, 6, v0
  v_and_b32 v3, 31, v0
  v_bfe_u32 v4, v0, 5, 1
  s_nop 0
  v_readfirstlane_b32 s16, v1
  s_lshl_b32 s17, s2, 2
  s_add_u32 s16, s16, s17
  s_lshl_b32 s18, s16, 13
  s_add_u32 s19, s18, 0x1930000
  s_add_u32 s20, s18, 0x2930000
  s_add_u32 s21, s18, 0x3930000
  s_lshl_b32 s18, s16, 11
  s_add_u32 s22, s18, 0x5930000
  s_add_u32 s23, s18, 0x5d30000
  s_mov_b32 s26, 0x000000ff
  s_mov_b32 s27, 0x000000ff
  s_mov_b32 s32, 0x3db504f3
  s_mov_b32 s33, 0x3fb8aa3b
  s_waitcnt lgkmcnt(0)
  s_and_b32 s5, s5, 0xffff
  s_mov_b32 s6, 0x10000000
  s_mov_b32 s7, 0x00020000
  v_lshlrev_b32 v5, 8, v3
  v_lshl_add_u32 v5, v4, 4, v5
  buffer_load_dwordx4 v[8:11], v5, s[4:7], s19 offen offset:0
  buffer_load_dwordx4 v[12:15], v5, s[4:7], s19 offen offset:32
  buffer_load_dwordx4 v[16:19], v5, s[4:7], s19 offen offset:64
  buffer_load_dwordx4 v[20:23], v5, s[4:7], s19 offen offset:96
  buffer_load_dwordx4 v[24:27], v5, s[4:7], s19 offen offset:128
  buffer_load_dwordx4 v[28:31], v5, s[4:7], s19 offen offset:160
  buffer_load_dwordx4 v[32:35], v5, s[4:7], s19 offen offset:192
  buffer_load_dwordx4 v[36:39], v5, s[4:7], s19 offen offset:224
  buffer_load_dwordx4 v[40:43], v5, s[4:7], s20 offen offset:0
  buffer_load_dwordx4 v[44:47], v5, s[4:7], s20 offen offset:32
  buffer_load_dwordx4 v[48:51], v5, s[4:7], s20 offen offset:64
  buffer_load_dwordx4 v[52:55], v5, s[4:7], s20 offen offset:96
  buffer_load_dwordx4 v[56:59], v5, s[4:7], s20 offen offset:128
  buffer_load_dwordx4 v[60:63], v5, s[4:7], s20 offen offset:160
  buffer_load_dwordx4 v[64:67], v5, s[4:7], s20 offen offset:192
  buffer_load_dwordx4 v[68:71], v5, s[4:7], s20 offen offset:224
  v_mov_b32 v72, 0
  v_mov_b32 v73, 0
  v_mov_b32 v74, 0
  v_mov_b32 v75, 0
  v_mov_b32 v76, 0
  v_mov_b32 v77, 0
  v_mov_b32 v78, 0
  v_mov_b32 v79, 0
  v_mov_b32 v80, 0
  v_mov_b32 v81, 0
  v_mov_b32 v82, 0
  v_mov_b32 v83, 0
  v_mov_b32 v84, 0
  v_mov_b32 v85, 0
  v_mov_b32 v86, 0
  v_mov_b32 v87, 0
  v_mov_b32 v88, 0
  v_mov_b32 v89, 0
  v_mov_b32 v90, 0
  v_mov_b32 v91, 0
  v_mov_b32 v92, 0
  v_mov_b32 v93, 0
  v_mov_b32 v94, 0
  v_mov_b32 v95, 0
  v_mov_b32 v96, 0
  v_mov_b32 v97, 0
  v_mov_b32 v98, 0
  v_mov_b32 v99, 0
  v_mov_b32 v100, 0
  v_mov_b32 v101, 0
  v_mov_b32 v102, 0
  v_mov_b32 v103, 0
  s_mov_b64 exec, s[26:27]
  buffer_load_dwordx4 v[72:75], v5, s[4:7], s22 offen offset:0
  buffer_load_dwordx4 v[76:79], v5, s[4:7], s22 offen offset:32
  buffer_load_dwordx4 v[80:83], v5, s[4:7], s22 offen offset:64
  buffer_load_dwordx4 v[84:87], v5, s[4:7], s22 offen offset:96
  buffer_load_dwordx4 v[88:91], v5, s[4:7], s22 offen offset:128
  buffer_load_dwordx4 v[92:95], v5, s[4:7], s22 offen offset:160
  buffer_load_dwordx4 v[96:99], v5, s[4:7], s22 offen offset:192
  buffer_load_dwordx4 v[100:103], v5, s[4:7], s22 offen offset:224
  s_mov_b64 exec, -1
  s_waitcnt vmcnt(8)
  v_mfma_f32_32x32x16_bf16 v[104:119], v[40:43], v[8:11], 0
  v_mfma_f32_32x32x16_bf16 v[104:119], v[44:47], v[12:15], v[104:119]
  v_mfma_f32_32x32x16_bf16 v[104:119], v[48:51], v[16:19], v[104:119]
  v_mfma_f32_32x32x16_bf16 v[104:119], v[52:55], v[20:23], v[104:119]
  v_mfma_f32_32x32x16_bf16 v[104:119], v[56:59], v[24:27], v[104:119]
  v_mfma_f32_32x32x16_bf16 v[104:119], v[60:63], v[28:31], v[104:119]
  v_mfma_f32_32x32x16_bf16 v[104:119], v[64:67], v[32:35], v[104:119]
  v_mfma_f32_32x32x16_bf16 v[104:119], v[68:71], v[36:39], v[104:119]
  s_waitcnt vmcnt(0)
  v_mfma_f32_32x32x16_bf16 v[120:135], v[72:75], v[8:11], 0
  v_mfma_f32_32x32x16_bf16 v[120:135], v[76:79], v[12:15], v[120:135]
  v_mfma_f32_32x32x16_bf16 v[120:135], v[80:83], v[16:19], v[120:135]
  v_mfma_f32_32x32x16_bf16 v[120:135], v[84:87], v[20:23], v[120:135]
  v_mfma_f32_32x32x16_bf16 v[120:135], v[88:91], v[24:27], v[120:135]
  v_mfma_f32_32x32x16_bf16 v[120:135], v[92:95], v[28:31], v[120:135]
  v_mfma_f32_32x32x16_bf16 v[120:135], v[96:99], v[32:35], v[120:135]
  v_mfma_f32_32x32x16_bf16 v[120:135], v[100:103], v[36:39], v[120:135]
  s_nop 15
  s_nop 15
  v_lshlrev_b32 v6, 6, v3
  v_lshl_add_u32 v6, v4, 3, v6
  v_lshlrev_b32 v7, 4, v3
  v_lshl_add_u32 v7, v4, 3, v7
  v_add_u32 v1, 0x1000, v6
  buffer_load_dwordx2 v[8:9], v6, s[4:7], s21 offen offset:0
  buffer_load_dwordx2 v[10:11], v6, s[4:7], s21 offen offset:16
  buffer_load_dwordx2 v[12:13], v6, s[4:7], s21 offen offset:32
  buffer_load_dwordx2 v[14:15], v6, s[4:7], s21 offen offset:48
  buffer_load_dwordx2 v[16:17], v6, s[4:7], s21 offen offset:2048
  buffer_load_dwordx2 v[18:19], v6, s[4:7], s21 offen offset:2064
  buffer_load_dwordx2 v[20:21], v6, s[4:7], s21 offen offset:2080
  buffer_load_dwordx2 v[22:23], v6, s[4:7], s21 offen offset:2096
  buffer_load_dwordx2 v[24:25], v1, s[4:7], s21 offen offset:0
  buffer_load_dwordx2 v[26:27], v1, s[4:7], s21 offen offset:16
  buffer_load_dwordx2 v[28:29], v1, s[4:7], s21 offen offset:32
  buffer_load_dwordx2 v[30:31], v1, s[4:7], s21 offen offset:48
  buffer_load_dwordx2 v[32:33], v1, s[4:7], s21 offen offset:2048
  buffer_load_dwordx2 v[34:35], v1, s[4:7], s21 offen offset:2064
  buffer_load_dwordx2 v[36:37], v1, s[4:7], s21 offen offset:2080
  buffer_load_dwordx2 v[38:39], v1, s[4:7], s21 offen offset:2096
  buffer_load_dwordx2 v[40:41], v7, s[4:7], s23 offen offset:0
  v_mov_b32 v42, 0
  v_mov_b32 v43, 0
  buffer_load_dwordx2 v[44:45], v7, s[4:7], s23 offen offset:512
  v_mov_b32 v46, 0
  v_mov_b32 v47, 0
  buffer_load_dwordx2 v[48:49], v7, s[4:7], s23 offen offset:1024
  v_mov_b32 v50, 0
  v_mov_b32 v51, 0
  buffer_load_dwordx2 v[52:53], v7, s[4:7], s23 offen offset:1536
  v_mov_b32 v54, 0
  v_mov_b32 v55, 0
  v_cvt_pk_bf16_f32 v136, v104, v105
  v_lshlrev_b32 v104, 16, v136
  v_and_b32 v105, 0xffff0000, v136
  v_cvt_pk_bf16_f32 v136, v106, v107
  v_lshlrev_b32 v106, 16, v136
  v_and_b32 v107, 0xffff0000, v136
  v_cvt_pk_bf16_f32 v136, v108, v109
  v_lshlrev_b32 v108, 16, v136
  v_and_b32 v109, 0xffff0000, v136
  v_cvt_pk_bf16_f32 v136, v110, v111
  v_lshlrev_b32 v110, 16, v136
  v_and_b32 v111, 0xffff0000, v136
  v_cvt_pk_bf16_f32 v136, v112, v113
  v_lshlrev_b32 v112, 16, v136
  v_and_b32 v113, 0xffff0000, v136
  v_cvt_pk_bf16_f32 v136, v114, v115
  v_lshlrev_b32 v114, 16, v136
  v_and_b32 v115, 0xffff0000, v136
  v_cvt_pk_bf16_f32 v136, v116, v117
  v_lshlrev_b32 v116, 16, v136
  v_and_b32 v117, 0xffff0000, v136
  v_cvt_pk_bf16_f32 v136, v118, v119
  v_lshlrev_b32 v118, 16, v136
  v_and_b32 v119, 0xffff0000, v136
  v_cvt_pk_bf16_f32 v136, v120, v121
  v_lshlrev_b32 v120, 16, v136
  v_and_b32 v121, 0xffff0000, v136
  v_cvt_pk_bf16_f32 v136, v122, v123
  v_lshlrev_b32 v122, 16, v136
  v_and_b32 v123, 0xffff0000, v136
  v_mul_f32 v104, s32, v104
  v_mul_f32 v105, s32, v105
  v_mul_f32 v106, s32, v106
  v_mul_f32 v107, s32, v107
  v_mul_f32 v108, s32, v108
  v_mul_f32 v109, s32, v109
  v_mul_f32 v110, s32, v110
  v_mul_f32 v111, s32, v111
  v_mul_f32 v112, s32, v112
  v_mul_f32 v113, s32, v113
  v_mul_f32 v114, s32, v114
  v_mul_f32 v115, s32, v115
  v_mul_f32 v116, s32, v116
  v_mul_f32 v117, s32, v117
  v_mul_f32 v118, s32, v118
  v_mul_f32 v119, s32, v119
  v_mul_f32 v120, s32, v120
  v_mul_f32 v121, s32, v121
  v_mul_f32 v122, s32, v122
  v_mul_f32 v123, s32, v123
  v_cvt_pk_bf16_f32 v136, v104, v105
  v_lshlrev_b32 v104, 16, v136
  v_and_b32 v105, 0xffff0000, v136
  v_cvt_pk_bf16_f32 v136, v106, v107
  v_lshlrev_b32 v106, 16, v136
  v_and_b32 v107, 0xffff0000, v136
  v_cvt_pk_bf16_f32 v136, v108, v109
  v_lshlrev_b32 v108, 16, v136
  v_and_b32 v109, 0xffff0000, v136
  v_cvt_pk_bf16_f32 v136, v110, v111
  v_lshlrev_b32 v110, 16, v136
  v_and_b32 v111, 0xffff0000, v136
  v_cvt_pk_bf16_f32 v136, v112, v113
  v_lshlrev_b32 v112, 16, v136
  v_and_b32 v113, 0xffff0000, v136
  v_cvt_pk_bf16_f32 v136, v114, v115
  v_lshlrev_b32 v114, 16, v136
  v_and_b32 v115, 0xffff0000, v136
  v_cvt_pk_bf16_f32 v136, v116, v117
  v_lshlrev_b32 v116, 16, v136
  v_and_b32 v117, 0xffff0000, v136
  v_cvt_pk_bf16_f32 v136, v118, v119
  v_lshlrev_b32 v118, 16, v136
  v_and_b32 v119, 0xffff0000, v136
  v_cvt_pk_bf16_f32 v136, v120, v121
  v_lshlrev_b32 v120, 16, v136
  v_and_b32 v121, 0xffff0000, v136
  v_cvt_pk_bf16_f32 v136, v122, v123
  v_lshlrev_b32 v122, 16, v136
  v_and_b32 v123, 0xffff0000, v136
  v_lshlrev_b32 v137, 2, v4
  v_sub_u32 v137, v3, v137
  v_mov_b32 v138, 0xff800000
  v_cmp_le_i32 vcc, 0, v137
  v_cndmask_b32 v104, v138, v104, vcc
  v_cmp_le_i32 vcc, 1, v137
  v_cndmask_b32 v105, v138, v105, vcc
  v_cmp_le_i32 vcc, 2, v137
  v_cndmask_b32 v106, v138, v106, vcc
  v_cmp_le_i32 vcc, 3, v137
  v_cndmask_b32 v107, v138, v107, vcc
  v_cmp_le_i32 vcc, 8, v137
  v_cndmask_b32 v108, v138, v108, vcc
  v_cmp_le_i32 vcc, 9, v137
  v_cndmask_b32 v109, v138, v109, vcc
  v_cmp_le_i32 vcc, 10, v137
  v_cndmask_b32 v110, v138, v110, vcc
  v_cmp_le_i32 vcc, 11, v137
  v_cndmask_b32 v111, v138, v111, vcc
  v_cmp_le_i32 vcc, 16, v137
  v_cndmask_b32 v112, v138, v112, vcc
  v_cmp_le_i32 vcc, 17, v137
  v_cndmask_b32 v113, v138, v113, vcc
  v_cmp_le_i32 vcc, 18, v137
  v_cndmask_b32 v114, v138, v114, vcc
  v_cmp_le_i32 vcc, 19, v137
  v_cndmask_b32 v115, v138, v115, vcc
  v_cmp_le_i32 vcc, 24, v137
  v_cndmask_b32 v116, v138, v116, vcc
  v_cmp_le_i32 vcc, 25, v137
  v_cndmask_b32 v117, v138, v117, vcc
  v_cmp_le_i32 vcc, 26, v137
  v_cndmask_b32 v118, v138, v118, vcc
  v_cmp_le_i32 vcc, 27, v137
  v_cndmask_b32 v119, v138, v119, vcc
  v_max3_f32 v139, v104, v105, v106
  v_max3_f32 v139, v139, v107, v108
  v_max3_f32 v139, v139, v109, v110
  v_max3_f32 v139, v139, v111, v112
  v_max3_f32 v139, v139, v113, v114
  v_max3_f32 v139, v139, v115, v116
  v_max3_f32 v139, v139, v117, v118
  v_max3_f32 v139, v139, v119, v120
  v_max3_f32 v139, v139, v121, v122
  v_max_f32 v139, v139, v123
  v_mov_b32 v140, v139
  s_nop 1
  v_permlane32_swap_b32 v139, v140
  v_max_f32 v139, v139, v140
  v_mul_f32 v139, s33, v139
  v_fma_f32 v104, v104, s33, -v139
  v_fma_f32 v105, v105, s33, -v139
  v_fma_f32 v106, v106, s33, -v139
  v_fma_f32 v107, v107, s33, -v139
  v_fma_f32 v108, v108, s33, -v139
  v_fma_f32 v109, v109, s33, -v139
  v_fma_f32 v110, v110, s33, -v139
  v_fma_f32 v111, v111, s33, -v139
  v_fma_f32 v112, v112, s33, -v139
  v_fma_f32 v113, v113, s33, -v139
  v_fma_f32 v114, v114, s33, -v139
  v_fma_f32 v115, v115, s33, -v139
  v_fma_f32 v116, v116, s33, -v139
  v_fma_f32 v117, v117, s33, -v139
  v_fma_f32 v118, v118, s33, -v139
  v_fma_f32 v119, v119, s33, -v139
  v_fma_f32 v120, v120, s33, -v139
  v_fma_f32 v121, v121, s33, -v139
  v_fma_f32 v122, v122, s33, -v139
  v_fma_f32 v123, v123, s33, -v139
  v_exp_f32 v104, v104
  v_exp_f32 v105, v105
  v_exp_f32 v106, v106
  v_exp_f32 v107, v107
  v_exp_f32 v108, v108
  v_exp_f32 v109, v109
  v_exp_f32 v110, v110
  v_exp_f32 v111, v111
  v_exp_f32 v112, v112
  v_exp_f32 v113, v113
  v_exp_f32 v114, v114
  v_exp_f32 v115, v115
  v_exp_f32 v116, v116
  v_exp_f32 v117, v117
  v_exp_f32 v118, v118
  v_exp_f32 v119, v119
  v_exp_f32 v120, v120
  v_exp_f32 v121, v121
  v_exp_f32 v122, v122
  v_exp_f32 v123, v123
  s_nop 0
  v_add_f32 v139, v104, v105
  v_add_f32 v139, v139, v106
  v_add_f32 v139, v139, v107
  v_add_f32 v139, v139, v108
  v_add_f32 v139, v139, v109
  v_add_f32 v139, v139, v110
  v_add_f32 v139, v139, v111
  v_add_f32 v139, v139, v112
  v_add_f32 v139, v139, v113
  v_add_f32 v139, v139, v114
  v_add_f32 v139, v139, v115
  v_add_f32 v139, v139, v116
  v_add_f32 v139, v139, v117
  v_add_f32 v139, v139, v118
  v_add_f32 v139, v139, v119
  v_add_f32 v139, v139, v120
  v_add_f32 v139, v139, v121
  v_add_f32 v139, v139, v122
  v_add_f32 v139, v139, v123
  v_mov_b32 v140, v139
  s_nop 1
  v_permlane32_swap_b32 v139, v140
  v_add_f32 v139, v139, v140
  v_rcp_f32 v140, v139
  s_nop 0
  v_fma_f32 v141, -v139, v140, 1.0
  v_fma_f32 v140, v141, v140, v140
  v_mul_f32 v104, v104, v140
  v_mul_f32 v105, v105, v140
  v_mul_f32 v106, v106, v140
  v_mul_f32 v107, v107, v140
  v_mul_f32 v108, v108, v140
  v_mul_f32 v109, v109, v140
  v_mul_f32 v110, v110, v140
  v_mul_f32 v111, v111, v140
  v_mul_f32 v112, v112, v140
  v_mul_f32 v113, v113, v140
  v_mul_f32 v114, v114, v140
  v_mul_f32 v115, v115, v140
  v_mul_f32 v116, v116, v140
  v_mul_f32 v117, v117, v140
  v_mul_f32 v118, v118, v140
  v_mul_f32 v119, v119, v140
  v_mul_f32 v120, v120, v140
  v_mul_f32 v121, v121, v140
  v_mul_f32 v122, v122, v140
  v_mul_f32 v123, v123, v140
  v_cvt_pk_bf16_f32 v152, v104, v105
  v_cvt_pk_bf16_f32 v153, v106, v107
  v_cvt_pk_bf16_f32 v154, v108, v109
  v_cvt_pk_bf16_f32 v155, v110, v111
  v_cvt_pk_bf16_f32 v156, v112, v113
  v_cvt_pk_bf16_f32 v157, v114, v115
  v_cvt_pk_bf16_f32 v158, v116, v117
  v_cvt_pk_bf16_f32 v159, v118, v119
  v_cvt_pk_bf16_f32 v160, v120, v121
  v_cvt_pk_bf16_f32 v161, v122, v123
  v_mov_b32 v162, 0
  v_mov_b32 v163, 0
  s_waitcnt vmcnt(0)
  s_nop 1
  v_mfma_f32_32x32x16_bf16 v[164:179], v[8:11], v[152:155], 0
  v_mfma_f32_32x32x16_bf16 v[164:179], v[12:15], v[156:159], v[164:179]
  v_mfma_f32_32x32x16_bf16 v[164:179], v[40:43], v[160:163], v[164:179]
  v_mfma_f32_32x32x16_bf16 v[180:195], v[16:19], v[152:155], 0
  v_mfma_f32_32x32x16_bf16 v[180:195], v[20:23], v[156:159], v[180:195]
  v_mfma_f32_32x32x16_bf16 v[180:195], v[44:47], v[160:163], v[180:195]
  v_mfma_f32_32x32x16_bf16 v[196:211], v[24:27], v[152:155], 0
  v_mfma_f32_32x32x16_bf16 v[196:211], v[28:31], v[156:159], v[196:211]
  v_mfma_f32_32x32x16_bf16 v[196:211], v[48:51], v[160:163], v[196:211]
  v_mfma_f32_32x32x16_bf16 v[212:227], v[32:35], v[152:155], 0
  v_mfma_f32_32x32x16_bf16 v[212:227], v[36:39], v[156:159], v[212:227]
  v_mfma_f32_32x32x16_bf16 v[212:227], v[52:55], v[160:163], v[212:227]
  s_nop 15
  s_lshr_b32 s24, s16, 5
  s_lshl_b32 s24, s24, 18
  s_and_b32 s25, s16, 31
  s_lshl_b32 s25, s25, 8
  s_add_u32 s24, s24, s25
  s_add_u32 s24, s24, 0x4930000
  v_lshlrev_b32 v5, 13, v3
  v_lshl_add_u32 v5, v4, 3, v5
  v_cvt_pk_bf16_f32 v136, v164, v165
  v_cvt_pk_bf16_f32 v137, v166, v167
  buffer_store_dwordx2 v[136:137], v5, s[4:7], s24 offen offset:0
  s_nop 0
  v_cvt_pk_bf16_f32 v136, v168, v169
  v_cvt_pk_bf16_f32 v137, v170, v171
  buffer_store_dwordx2 v[136:137], v5, s[4:7], s24 offen offset:16
  s_nop 0
  v_cvt_pk_bf16_f32 v136, v172, v173
  v_cvt_pk_bf16_f32 v137, v174, v175
  buffer_store_dwordx2 v[136:137], v5, s[4:7], s24 offen offset:32
  s_nop 0
  v_cvt_pk_bf16_f32 v136, v176, v177
  v_cvt_pk_bf16_f32 v137, v178, v179
  buffer_store_dwordx2 v[136:137], v5, s[4:7], s24 offen offset:48
  s_nop 0
  v_cvt_pk_bf16_f32 v136, v180, v181
  v_cvt_pk_bf16_f32 v137, v182, v183
  buffer_store_dwordx2 v[136:137], v5, s[4:7], s24 offen offset:64
  s_nop 0
  v_cvt_pk_bf16_f32 v136, v184, v185
  v_cvt_pk_bf16_f32 v137, v186, v187
  buffer_store_dwordx2 v[136:137], v5, s[4:7], s24 offen offset:80
  s_nop 0
  v_cvt_pk_bf16_f32 v136, v188, v189
  v_cvt_pk_bf16_f32 v137, v190, v191
  buffer_store_dwordx2 v[136:137], v5, s[4:7], s24 offen offset:96
  s_nop 0
  v_cvt_pk_bf16_f32 v136, v192, v193
  v_cvt_pk_bf16_f32 v137, v194, v195
  buffer_store_dwordx2 v[136:137], v5, s[4:7], s24 offen offset:112
  s_nop 0
  v_cvt_pk_bf16_f32 v136, v196, v197
  v_cvt_pk_bf16_f32 v137, v198, v199
  buffer_store_dwordx2 v[136:137], v5, s[4:7], s24 offen offset:128
  s_nop 0
  v_cvt_pk_bf16_f32 v136, v200, v201
  v_cvt_pk_bf16_f32 v137, v202, v203
  buffer_store_dwordx2 v[136:137], v5, s[4:7], s24 offen offset:144
  s_nop 0
  v_cvt_pk_bf16_f32 v136, v204, v205
  v_cvt_pk_bf16_f32 v137, v206, v207
  buffer_store_dwordx2 v[136:137], v5, s[4:7], s24 offen offset:160
  s_nop 0
  v_cvt_pk_bf16_f32 v136, v208, v209
  v_cvt_pk_bf16_f32 v137, v210, v211
  buffer_store_dwordx2 v[136:137], v5, s[4:7], s24 offen offset:176
  s_nop 0
  v_cvt_pk_bf16_f32 v136, v212, v213
  v_cvt_pk_bf16_f32 v137, v214, v215
  buffer_store_dwordx2 v[136:137], v5, s[4:7], s24 offen offset:192
  s_nop 0
  v_cvt_pk_bf16_f32 v136, v216, v217
  v_cvt_pk_bf16_f32 v137, v218, v219
  buffer_store_dwordx2 v[136:137], v5, s[4:7], s24 offen offset:208
  s_nop 0
  v_cvt_pk_bf16_f32 v136, v220, v221
  v_cvt_pk_bf16_f32 v137, v222, v223
  buffer_store_dwordx2 v[136:137], v5, s[4:7], s24 offen offset:224
  s_nop 0
  v_cvt_pk_bf16_f32 v136, v224, v225
  v_cvt_pk_bf16_f32 v137, v226, v227
  buffer_store_dwordx2 v[136:137], v5, s[4:7], s24 offen offset:240
  s_nop 0
  .Lattnb_kernel_end1:
  s_endpgm

.section .rodata,"a"
.p2align 6
.amdhsa_kernel tr_kernel
  .amdhsa_next_free_vgpr 48
  .amdhsa_next_free_sgpr 32
  .amdhsa_accum_offset 48
  .amdhsa_group_segment_fixed_size 0
  .amdhsa_kernarg_size 120
  .amdhsa_user_sgpr_count 2
  .amdhsa_user_sgpr_kernarg_segment_ptr 1
  .amdhsa_system_sgpr_workgroup_id_x 1
.end_amdhsa_kernel

.p2align 6
.amdhsa_kernel ln_kernel
  .amdhsa_next_free_vgpr 40
  .amdhsa_next_free_sgpr 32
  .amdhsa_accum_offset 40
  .amdhsa_group_segment_fixed_size 0
  .amdhsa_kernarg_size 120
  .amdhsa_user_sgpr_count 2
  .amdhsa_user_sgpr_kernarg_segment_ptr 1
  .amdhsa_system_sgpr_workgroup_id_x 1
.end_amdhsa_kernel

.p2align 6
.amdhsa_kernel g1_kernel
  .amdhsa_next_free_vgpr 196
  .amdhsa_next_free_sgpr 40
  .amdhsa_accum_offset 196
  .amdhsa_group_segment_fixed_size 0
  .amdhsa_kernarg_size 120
  .amdhsa_user_sgpr_count 2
  .amdhsa_user_sgpr_kernarg_segment_ptr 1
  .amdhsa_system_sgpr_workgroup_id_x 1
.end_amdhsa_kernel

.p2align 6
.amdhsa_kernel g2_kernel
  .amdhsa_next_free_vgpr 96
  .amdhsa_next_free_sgpr 40
  .amdhsa_accum_offset 96
  .amdhsa_group_segment_fixed_size 0
  .amdhsa_kernarg_size 120
  .amdhsa_user_sgpr_count 2
  .amdhsa_user_sgpr_kernarg_segment_ptr 1
  .amdhsa_system_sgpr_workgroup_id_x 1
.end_amdhsa_kernel

.p2align 6
.amdhsa_kernel g3_kernel
  .amdhsa_next_free_vgpr 196
  .amdhsa_next_free_sgpr 40
  .amdhsa_accum_offset 196
  .amdhsa_group_segment_fixed_size 0
  .amdhsa_kernarg_size 120
  .amdhsa_user_sgpr_count 2
  .amdhsa_user_sgpr_kernarg_segment_ptr 1
  .amdhsa_system_sgpr_workgroup_id_x 1
.end_amdhsa_kernel

.p2align 6
.amdhsa_kernel g4_kernel
  .amdhsa_next_free_vgpr 96
  .amdhsa_next_free_sgpr 40
  .amdhsa_accum_offset 96
  .amdhsa_group_segment_fixed_size 0
  .amdhsa_kernarg_size 120
  .amdhsa_user_sgpr_count 2
  .amdhsa_user_sgpr_kernarg_segment_ptr 1
  .amdhsa_system_sgpr_workgroup_id_x 1
.end_amdhsa_kernel

.p2align 6
.amdhsa_kernel attna_kernel
  .amdhsa_next_free_vgpr 160
  .amdhsa_next_free_sgpr 40
  .amdhsa_accum_offset 160
  .amdhsa_group_segment_fixed_size 0
  .amdhsa_kernarg_size 120
  .amdhsa_user_sgpr_count 2
  .amdhsa_user_sgpr_kernarg_segment_ptr 1
  .amdhsa_system_sgpr_workgroup_id_x 1
.end_amdhsa_kernel

.p2align 6
.amdhsa_kernel chain_kernel
  .amdhsa_next_free_vgpr 512
  .amdhsa_next_free_sgpr 48
  .amdhsa_accum_offset 256
  .amdhsa_group_segment_fixed_size 0
  .amdhsa_kernarg_size 120
  .amdhsa_user_sgpr_count 2
  .amdhsa_user_sgpr_kernarg_segment_ptr 1
  .amdhsa_system_sgpr_workgroup_id_x 1
.end_amdhsa_kernel

.p2align 6
.amdhsa_kernel attnb_kernel
  .amdhsa_next_free_vgpr 228
  .amdhsa_next_free_sgpr 40
  .amdhsa_accum_offset 228
  .amdhsa_group_segment_fixed_size 0
  .amdhsa_kernarg_size 120
  .amdhsa_user_sgpr_count 2
  .amdhsa_user_sgpr_kernarg_segment_ptr 1
  .amdhsa_system_sgpr_workgroup_id_x 1
.end_amdhsa_kernel
```
